```python
import torch

def _softmax(x, axis=-1):
    return torch.softmax(x, dim=axis)
def _gelu(x):
    return torch.nn.functional.gelu(x, approximate="tanh")
def _silu(x):
    return torch.nn.functional.silu(x)
def _sigmoid(x):
    return torch.sigmoid(x)
def _layernorm(x, axis=-1, eps=1e-5):
    m = x.mean(dim=axis, keepdim=True)
    v = x.var(dim=axis, keepdim=True, unbiased=False)
    return (x - m) / torch.sqrt(v + eps)
def _scatter_add(tgt, idx, src, axis=0):
    return tgt.clone().index_add_(axis, idx, src)
def _segment_sum(src, seg, n):
    out = torch.zeros((n,) + src.shape[1:], dtype=src.dtype)
    return out.index_add_(0, seg, src)
def _pad(x, pw):
    flat = tuple(v for pair in reversed(pw) for v in pair)
    return torch.nn.functional.pad(x, flat)

kernel_name = 'standalone__gqa_softmax__near_ridge'

def setup_inputs():

    _w = (lambda a: (lambda t: t.to(torch.bfloat16) if t.is_floating_point() else t)(torch.as_tensor(a)))
    B, Hq, Hkv, Sq, Sk, D = 8, 32, 4, 48, 2048, 128
    return {
        "q": _w((lambda *s: torch.randn(*s, dtype=torch.bfloat16) * 0.8)(B, Hq, Sq, D)),
        "k": _w((lambda *s: torch.randn(*s, dtype=torch.bfloat16) * 0.8)(B, Hkv, Sk, D)),
        "v": _w((lambda *s: torch.randn(*s, dtype=torch.bfloat16) * 0.05)(B, Hkv, Sk, D)),
    }

def reference(q, k, v):
    B, Hq, Sq, D = q.shape
    Hkv = k.shape[1]
    rep = Hq // Hkv
    k = (lambda x, n, axis: torch.repeat_interleave(x, n, dim=axis))(k, rep, axis=1)
    v = (lambda x, n, axis: torch.repeat_interleave(x, n, dim=axis))(v, rep, axis=1)
    scale = D ** -0.5
    scores = torch.einsum("bhqd,bhkd->bhqk", q, k) * scale
    p = _softmax(scores, axis=-1)
    return torch.einsum("bhqk,bhkd->bhqd", p, v)
```

```asm
; @launch kernel=standalone__gqa_softmax__near_ridge_kernel grid=(256,1,1) block=(512,1,1) lds=163840
; @launch kernel=gqa_combine_kernel grid=(256,1,1) block=(256,1,1) lds=0
.amdgcn_target "amdgcn-amd-amdhsa--gfx950"
.text
.globl standalone__gqa_softmax__near_ridge_kernel
.p2align 8
.type standalone__gqa_softmax__near_ridge_kernel,@function
standalone__gqa_softmax__near_ridge_kernel:
    s_cmp_ge_u32 s2, 256
    s_cbranch_scc1 L_done
    s_load_dwordx4 s[28:31], s[0:1], 0
    s_load_dwordx2 s[32:33], s[0:1], 16
    s_load_dwordx2 s[34:35], s[0:1], 40
    v_lshrrev_b32 v1, 6, v0
    v_and_b32 v0, 63, v0
    s_nop 0
    v_readfirstlane_b32 s27, v1
    s_and_b32 s3, s2, 7
    s_lshl_b32 s3, s3, 2
    s_lshr_b32 s36, s2, 6
    s_add_u32 s3, s3, s36
    s_lshr_b32 s36, s2, 5
    s_and_b32 s36, s36, 1
    s_lshr_b32 s37, s2, 3
    s_and_b32 s37, s37, 3
    s_and_b32 s52, s27, 3
    s_lshr_b32 s53, s27, 2
    s_lshr_b32 s56, s52, 1
    s_and_b32 s57, s52, 1
    s_lshl_b32 s54, s3, 1
    s_add_u32 s54, s54, s36
    s_lshl_b32 s55, s54, 2
    s_add_u32 s54, s55, s37
    s_add_u32 s55, s55, s52
    s_mul_i32 s38, s55, 12288
    s_lshl_b32 s39, s3, 19
    s_lshl_b32 s40, s37, 17
    s_add_u32 s39, s39, s40
    v_and_b32 v23, 15, v0
    v_lshrrev_b32 v24, 4, v0
    v_lshlrev_b32 v25, s56, v24
    v_xor_b32 v25, v23, v25
    v_lshlrev_b32 v25, 4, v25
    v_lshl_add_u32 v1, v24, 8, v25
    s_cmp_eq_u32 s56, 0
    s_cselect_b32 s58, 0x40, 0x80
    s_cselect_b32 s59, 0x80, 0
    s_cselect_b32 s63, 0x40, 0
    s_add_u32 s63, s63, 0x80
    v_xor_b32 v2, s58, v1
    v_xor_b32 v3, s59, v1
    v_xor_b32 v4, s63, v1
    s_lshl_b32 s41, s53, 15
    v_xor_b32 v25, v23, v24
    v_lshlrev_b32 v25, 4, v25
    v_lshl_add_u32 v25, v23, 8, v25
    v_add_u32 v5, s41, v25
    v_xor_b32 v6, 64, v5
    v_xor_b32 v7, 128, v5
    v_xor_b32 v8, 192, v5
    v_lshrrev_b32 v25, 2, v0
    v_and_b32 v26, 7, v25
    v_lshlrev_b32 v26, 5, v26
    v_lshl_add_u32 v26, v25, 8, v26
    v_and_b32 v25, 3, v0
    v_lshl_add_u32 v26, v25, 3, v26
    s_lshl_b32 s42, s53, 13
    s_add_u32 s42, s42, 65536
    v_add_u32 v9, s42, v26
    s_lshl_b32 s44, s53, 7
    v_xor_b32 v9, s44, v9
    v_xor_b32 v10, 32, v9
    v_xor_b32 v11, 64, v9
    v_xor_b32 v12, 96, v9
    v_xor_b32 v13, 128, v9
    v_xor_b32 v14, 160, v9
    v_xor_b32 v15, 192, v9
    v_xor_b32 v16, 224, v9
    s_mov_b32 s20, 0x3e0293ee
    s_lshl_b32 s21, s53, 13
    s_lshl_b32 s44, s57, 12
    s_add_u32 s21, s21, s44
    s_cmp_eq_u32 s56, 0
    s_cselect_b32 s43, s41, s42
    s_add_u32 s43, s43, s44
    s_lshl_b32 s48, 0x2000, s56
    s_waitcnt lgkmcnt(0)
    s_cmp_eq_u32 s56, 0
    s_cselect_b32 s8, s30, s32
    s_cselect_b32 s9, s31, s33
    s_add_u32 s8, s8, s39
    s_addc_u32 s9, s9, 0
    s_mov_b32 s10, 0x20000
    s_mov_b32 s11, 0x00020000
    s_add_u32 s4, s28, s38
    s_addc_u32 s5, s29, 0
    s_mov_b32 s6, 12288
    s_mov_b32 s7, 0x00020000
    s_cmp_lg_u32 s56, 0
    s_cbranch_scc1 L_vr
    s_mov_b32 m0, s43
    s_nop 0
    buffer_load_dwordx4 v1, s[8:11], s21 offen offset:0 lds
    buffer_load_dwordx4 v2, s[8:11], s21 offen offset:1024 lds
    buffer_load_dwordx4 v3, s[8:11], s21 offen offset:2048 lds
    buffer_load_dwordx4 v4, s[8:11], s21 offen offset:3072 lds
    s_add_u32 s21, s21, 16384
    v_xor_b32 v28, v23, v24
    v_lshlrev_b32 v28, 4, v28
    v_lshl_add_u32 v28, v24, 8, v28
    s_lshl_b32 s44, s53, 7
    v_xor_b32 v28, s44, v28
    v_xor_b32 v27, 0x40, v28
    s_lshl_b32 s44, s53, 11
    s_mul_i32 s45, s52, 12288
    s_add_u32 s45, s45, s44
    s_add_u32 s45, s45, 114688
    s_add_u32 m0, s45, 0
    s_nop 0
    buffer_load_dwordx4 v28, s[4:7], s44 offen lds
    buffer_load_dwordx4 v27, s[4:7], s44 offen offset:1024 lds
    s_add_u32 s44, s44, 4096
    s_add_u32 m0, s45, 4096
    s_nop 0
    buffer_load_dwordx4 v28, s[4:7], s44 offen lds
    buffer_load_dwordx4 v27, s[4:7], s44 offen offset:1024 lds
    s_add_u32 s44, s44, 4096
    s_add_u32 m0, s45, 8192
    s_nop 0
    buffer_load_dwordx4 v28, s[4:7], s44 offen lds
    buffer_load_dwordx4 v27, s[4:7], s44 offen offset:1024 lds
    s_add_u32 s44, s44, 4096
    s_add_u32 m0, s43, 8192
    s_nop 0
    buffer_load_dwordx4 v1, s[8:11], s21 offen offset:0 lds
    buffer_load_dwordx4 v2, s[8:11], s21 offen offset:1024 lds
    buffer_load_dwordx4 v3, s[8:11], s21 offen offset:2048 lds
    buffer_load_dwordx4 v4, s[8:11], s21 offen offset:3072 lds
    s_add_u32 s21, s21, 16384
    s_add_u32 m0, s43, 16384
    s_nop 0
    buffer_load_dwordx4 v1, s[8:11], s21 offen offset:0 lds
    buffer_load_dwordx4 v2, s[8:11], s21 offen offset:1024 lds
    buffer_load_dwordx4 v3, s[8:11], s21 offen offset:2048 lds
    buffer_load_dwordx4 v4, s[8:11], s21 offen offset:3072 lds
    s_add_u32 s21, s21, 16384
    s_add_u32 s25, s43, 24576
    s_branch L_pj
L_vr:
    v_xor_b32 v28, v23, v24
    v_lshlrev_b32 v28, 4, v28
    v_lshl_add_u32 v28, v24, 8, v28
    s_lshl_b32 s44, s53, 7
    v_xor_b32 v28, s44, v28
    v_xor_b32 v27, 0x40, v28
    s_lshl_b32 s44, s53, 11
    s_mul_i32 s45, s52, 12288
    s_add_u32 s45, s45, s44
    s_add_u32 s45, s45, 114688
    s_add_u32 m0, s45, 0
    s_nop 0
    buffer_load_dwordx4 v28, s[4:7], s44 offen lds
    buffer_load_dwordx4 v27, s[4:7], s44 offen offset:1024 lds
    s_add_u32 s44, s44, 4096
    s_add_u32 m0, s45, 4096
    s_nop 0
    buffer_load_dwordx4 v28, s[4:7], s44 offen lds
    buffer_load_dwordx4 v27, s[4:7], s44 offen offset:1024 lds
    s_add_u32 s44, s44, 4096
    s_add_u32 m0, s45, 8192
    s_nop 0
    buffer_load_dwordx4 v28, s[4:7], s44 offen lds
    buffer_load_dwordx4 v27, s[4:7], s44 offen offset:1024 lds
    s_add_u32 s44, s44, 4096
    s_add_u32 m0, s43, 0
    s_nop 0
    buffer_load_dwordx4 v1, s[8:11], s21 offen offset:0 lds
    buffer_load_dwordx4 v2, s[8:11], s21 offen offset:1024 lds
    buffer_load_dwordx4 v3, s[8:11], s21 offen offset:2048 lds
    buffer_load_dwordx4 v4, s[8:11], s21 offen offset:3072 lds
    s_add_u32 s21, s21, 16384
    s_add_u32 m0, s43, 16384
    s_nop 0
    buffer_load_dwordx4 v1, s[8:11], s21 offen offset:0 lds
    buffer_load_dwordx4 v2, s[8:11], s21 offen offset:1024 lds
    buffer_load_dwordx4 v3, s[8:11], s21 offen offset:2048 lds
    buffer_load_dwordx4 v4, s[8:11], s21 offen offset:3072 lds
    s_add_u32 s21, s21, 16384
    s_add_u32 s25, s43, 32768
L_pj:
    s_lshl_b32 s50, s48, 2
    s_add_u32 s50, s50, s43
    v_mov_b32 v17, 0xff800000
    v_mov_b32 v20, 0
    v_mov_b32 v18, 0xff800000
    v_mov_b32 v21, 0
    v_mov_b32 v19, 0xff800000
    v_mov_b32 v22, 0
    v_mov_b32 v160, 0
    v_mov_b32 v161, 0
    v_mov_b32 v162, 0
    v_mov_b32 v163, 0
    v_mov_b32 v164, 0
    v_mov_b32 v165, 0
    v_mov_b32 v166, 0
    v_mov_b32 v167, 0
    v_mov_b32 v168, 0
    v_mov_b32 v169, 0
    v_mov_b32 v170, 0
    v_mov_b32 v171, 0
    v_mov_b32 v172, 0
    v_mov_b32 v173, 0
    v_mov_b32 v174, 0
    v_mov_b32 v175, 0
    v_mov_b32 v176, 0
    v_mov_b32 v177, 0
    v_mov_b32 v178, 0
    v_mov_b32 v179, 0
    v_mov_b32 v180, 0
    v_mov_b32 v181, 0
    v_mov_b32 v182, 0
    v_mov_b32 v183, 0
    v_mov_b32 v184, 0
    v_mov_b32 v185, 0
    v_mov_b32 v186, 0
    v_mov_b32 v187, 0
    v_mov_b32 v188, 0
    v_mov_b32 v189, 0
    v_mov_b32 v190, 0
    v_mov_b32 v191, 0
    v_mov_b32 v192, 0
    v_mov_b32 v193, 0
    v_mov_b32 v194, 0
    v_mov_b32 v195, 0
    v_mov_b32 v196, 0
    v_mov_b32 v197, 0
    v_mov_b32 v198, 0
    v_mov_b32 v199, 0
    v_mov_b32 v200, 0
    v_mov_b32 v201, 0
    v_mov_b32 v202, 0
    v_mov_b32 v203, 0
    v_mov_b32 v204, 0
    v_mov_b32 v205, 0
    v_mov_b32 v206, 0
    v_mov_b32 v207, 0
    v_mov_b32 v208, 0
    v_mov_b32 v209, 0
    v_mov_b32 v210, 0
    v_mov_b32 v211, 0
    v_mov_b32 v212, 0
    v_mov_b32 v213, 0
    v_mov_b32 v214, 0
    v_mov_b32 v215, 0
    v_mov_b32 v216, 0
    v_mov_b32 v217, 0
    v_mov_b32 v218, 0
    v_mov_b32 v219, 0
    v_mov_b32 v220, 0
    v_mov_b32 v221, 0
    v_mov_b32 v222, 0
    v_mov_b32 v223, 0
    v_mov_b32 v224, 0
    v_mov_b32 v225, 0
    v_mov_b32 v226, 0
    v_mov_b32 v227, 0
    v_mov_b32 v228, 0
    v_mov_b32 v229, 0
    v_mov_b32 v230, 0
    v_mov_b32 v231, 0
    v_mov_b32 v232, 0
    v_mov_b32 v233, 0
    v_mov_b32 v234, 0
    v_mov_b32 v235, 0
    v_mov_b32 v236, 0
    v_mov_b32 v237, 0
    v_mov_b32 v238, 0
    v_mov_b32 v239, 0
    v_mov_b32 v240, 0
    v_mov_b32 v241, 0
    v_mov_b32 v242, 0
    v_mov_b32 v243, 0
    v_mov_b32 v244, 0
    v_mov_b32 v245, 0
    v_mov_b32 v246, 0
    v_mov_b32 v247, 0
    v_mov_b32 v248, 0
    v_mov_b32 v249, 0
    v_mov_b32 v250, 0
    v_mov_b32 v251, 0
    v_mov_b32 v252, 0
    v_mov_b32 v253, 0
    v_mov_b32 v254, 0
    v_mov_b32 v255, 0
    v_mov_b32 v136, 0
    v_mov_b32 v137, 0
    v_mov_b32 v138, 0
    v_mov_b32 v139, 0
    v_mov_b32 v144, 0
    v_mov_b32 v145, 0
    v_mov_b32 v146, 0
    v_mov_b32 v147, 0
    v_mov_b32 v152, 0
    v_mov_b32 v153, 0
    v_mov_b32 v154, 0
    v_mov_b32 v155, 0
    s_waitcnt vmcnt(8)
    s_barrier
    v_xor_b32 v28, v23, v24
    v_lshlrev_b32 v28, 4, v28
    v_lshl_add_u32 v28, v23, 8, v28
    s_mul_i32 s45, s52, 12288
    s_add_u32 s45, s45, 114688
    v_add_u32 v28, s45, v28
    v_xor_b32 v27, 0, v28
    ds_read_b128 v[32:35], v27 offset:0
    ds_read_b128 v[48:51], v27 offset:4096
    ds_read_b128 v[64:67], v27 offset:8192
    v_xor_b32 v27, 64, v28
    ds_read_b128 v[36:39], v27 offset:0
    ds_read_b128 v[52:55], v27 offset:4096
    ds_read_b128 v[68:71], v27 offset:8192
    v_xor_b32 v27, 128, v28
    ds_read_b128 v[40:43], v27 offset:0
    ds_read_b128 v[56:59], v27 offset:4096
    ds_read_b128 v[72:75], v27 offset:8192
    v_xor_b32 v27, 192, v28
    ds_read_b128 v[44:47], v27 offset:0
    ds_read_b128 v[60:63], v27 offset:4096
    ds_read_b128 v[76:79], v27 offset:8192
    ds_read_b128 v[80:83], v5 offset:0
    ds_read_b128 v[84:87], v6 offset:0
    ds_read_b128 v[88:91], v7 offset:0
    ds_read_b128 v[92:95], v8 offset:0
    ds_read_b128 v[96:99], v5 offset:4096
    ds_read_b128 v[100:103], v6 offset:4096
    ds_read_b128 v[104:107], v7 offset:4096
    ds_read_b128 v[108:111], v8 offset:4096
    s_waitcnt lgkmcnt(0)
    v_mfma_f32_16x16x32_bf16 v[112:115], v[80:83], v[32:35], 0
    v_mfma_f32_16x16x32_bf16 v[120:123], v[80:83], v[48:51], 0
    v_mfma_f32_16x16x32_bf16 v[128:131], v[80:83], v[64:67], 0
    v_mfma_f32_16x16x32_bf16 v[116:119], v[96:99], v[32:35], 0
    v_mfma_f32_16x16x32_bf16 v[124:127], v[96:99], v[48:51], 0
    v_mfma_f32_16x16x32_bf16 v[132:135], v[96:99], v[64:67], 0
    v_mfma_f32_16x16x32_bf16 v[112:115], v[84:87], v[36:39], v[112:115]
    v_mfma_f32_16x16x32_bf16 v[120:123], v[84:87], v[52:55], v[120:123]
    v_mfma_f32_16x16x32_bf16 v[128:131], v[84:87], v[68:71], v[128:131]
    v_mfma_f32_16x16x32_bf16 v[116:119], v[100:103], v[36:39], v[116:119]
    v_mfma_f32_16x16x32_bf16 v[124:127], v[100:103], v[52:55], v[124:127]
    v_mfma_f32_16x16x32_bf16 v[132:135], v[100:103], v[68:71], v[132:135]
    v_mfma_f32_16x16x32_bf16 v[112:115], v[88:91], v[40:43], v[112:115]
    v_mfma_f32_16x16x32_bf16 v[120:123], v[88:91], v[56:59], v[120:123]
    v_mfma_f32_16x16x32_bf16 v[128:131], v[88:91], v[72:75], v[128:131]
    v_mfma_f32_16x16x32_bf16 v[116:119], v[104:107], v[40:43], v[116:119]
    v_mfma_f32_16x16x32_bf16 v[124:127], v[104:107], v[56:59], v[124:127]
    v_mfma_f32_16x16x32_bf16 v[132:135], v[104:107], v[72:75], v[132:135]
    v_mfma_f32_16x16x32_bf16 v[112:115], v[92:95], v[44:47], v[112:115]
    v_mfma_f32_16x16x32_bf16 v[120:123], v[92:95], v[60:63], v[120:123]
    v_mfma_f32_16x16x32_bf16 v[128:131], v[92:95], v[76:79], v[128:131]
    v_mfma_f32_16x16x32_bf16 v[116:119], v[108:111], v[44:47], v[116:119]
    v_mfma_f32_16x16x32_bf16 v[124:127], v[108:111], v[60:63], v[124:127]
    v_mfma_f32_16x16x32_bf16 v[132:135], v[108:111], v[76:79], v[132:135]
    s_mov_b32 s26, 0
L_loop:
    s_waitcnt vmcnt(4)
    s_barrier
    v_max3_f32 v23, v112, v113, v114
    v_max3_f32 v23, v23, v115, v116
    v_max3_f32 v23, v23, v117, v118
    v_max_f32 v23, v23, v119
    v_fma_f32 v26, v23, s20, -v17
    v_max3_f32 v24, v120, v121, v122
    v_max3_f32 v24, v24, v123, v124
    v_max3_f32 v24, v24, v125, v126
    v_max_f32 v24, v24, v127
    v_fma_f32 v27, v24, s20, -v18
    v_max3_f32 v25, v128, v129, v130
    v_max3_f32 v25, v25, v131, v132
    v_max3_f32 v25, v25, v133, v134
    v_max_f32 v25, v25, v135
    v_fma_f32 v28, v25, s20, -v19
    v_max3_f32 v26, v26, v27, v28
    v_cmp_lt_f32 vcc, 0x41000000, v26
    s_cbranch_vccnz L_slow0
    s_waitcnt lgkmcnt(8)
    v_mfma_f32_16x16x32_bf16 v[160:163], v[80:83], v[136:139], v[160:163]
    v_fma_f32 v112, v112, s20, -v17
    v_fma_f32 v113, v113, s20, -v17
    v_mfma_f32_16x16x32_bf16 v[164:167], v[80:83], v[144:147], v[164:167]
    v_fma_f32 v114, v114, s20, -v17
    v_fma_f32 v115, v115, s20, -v17
    v_mfma_f32_16x16x32_bf16 v[168:171], v[80:83], v[152:155], v[168:171]
    v_fma_f32 v116, v116, s20, -v17
    v_fma_f32 v117, v117, s20, -v17
    s_mov_b32 m0, s25
    s_nop 0
    buffer_load_dwordx4 v1, s[8:11], s21 offen offset:0 lds
    buffer_load_dwordx4 v2, s[8:11], s21 offen offset:1024 lds
    buffer_load_dwordx4 v3, s[8:11], s21 offen offset:2048 lds
    buffer_load_dwordx4 v4, s[8:11], s21 offen offset:3072 lds
    s_add_u32 s21, s21, 16384
    s_add_u32 s25, s25, s48
    s_cmp_eq_u32 s25, s50
    s_cselect_b32 s25, s43, s25
    v_mfma_f32_16x16x32_bf16 v[172:175], v[84:87], v[136:139], v[172:175]
    v_fma_f32 v118, v118, s20, -v17
    v_mfma_f32_16x16x32_bf16 v[176:179], v[84:87], v[144:147], v[176:179]
    v_fma_f32 v119, v119, s20, -v17
    v_exp_f32 v112, v112
    v_mfma_f32_16x16x32_bf16 v[180:183], v[84:87], v[152:155], v[180:183]
    v_exp_f32 v113, v113
    v_exp_f32 v114, v114
    v_mfma_f32_16x16x32_bf16 v[184:187], v[88:91], v[136:139], v[184:187]
    v_exp_f32 v115, v115
    v_exp_f32 v116, v116
    v_mfma_f32_16x16x32_bf16 v[188:191], v[88:91], v[144:147], v[188:191]
    v_exp_f32 v117, v117
    v_mfma_f32_16x16x32_bf16 v[192:195], v[88:91], v[152:155], v[192:195]
    v_exp_f32 v118, v118
    v_exp_f32 v119, v119
    v_mfma_f32_16x16x32_bf16 v[196:199], v[92:95], v[136:139], v[196:199]
    v_add_f32 v20, v20, v112
    v_add_f32 v20, v20, v113
    v_mfma_f32_16x16x32_bf16 v[200:203], v[92:95], v[144:147], v[200:203]
    v_add_f32 v20, v20, v114
    v_add_f32 v20, v20, v115
    v_mfma_f32_16x16x32_bf16 v[204:207], v[92:95], v[152:155], v[204:207]
    v_add_f32 v20, v20, v116
    ds_read_b128 v[80:83], v5 offset:8192
    ds_read_b128 v[84:87], v6 offset:8192
    ds_read_b128 v[88:91], v7 offset:8192
    ds_read_b128 v[92:95], v8 offset:8192
    s_waitcnt lgkmcnt(4)
    v_mfma_f32_16x16x32_bf16 v[208:211], v[96:99], v[136:139], v[208:211]
    v_add_f32 v20, v20, v117
    v_add_f32 v20, v20, v118
    v_mfma_f32_16x16x32_bf16 v[212:215], v[96:99], v[144:147], v[212:215]
    v_add_f32 v20, v20, v119
    v_cvt_pk_bf16_f32 v112, v112, v113
    v_mfma_f32_16x16x32_bf16 v[216:219], v[96:99], v[152:155], v[216:219]
    v_cvt_pk_bf16_f32 v113, v114, v115
    v_cvt_pk_bf16_f32 v114, v116, v117
    v_mfma_f32_16x16x32_bf16 v[220:223], v[100:103], v[136:139], v[220:223]
    v_cvt_pk_bf16_f32 v115, v118, v119
    v_mfma_f32_16x16x32_bf16 v[224:227], v[100:103], v[144:147], v[224:227]
    v_fma_f32 v120, v120, s20, -v18
    v_fma_f32 v121, v121, s20, -v18
    v_mfma_f32_16x16x32_bf16 v[228:231], v[100:103], v[152:155], v[228:231]
    v_fma_f32 v122, v122, s20, -v18
    v_fma_f32 v123, v123, s20, -v18
    v_mfma_f32_16x16x32_bf16 v[232:235], v[104:107], v[136:139], v[232:235]
    v_fma_f32 v124, v124, s20, -v18
    v_fma_f32 v125, v125, s20, -v18
    v_mfma_f32_16x16x32_bf16 v[236:239], v[104:107], v[144:147], v[236:239]
    v_fma_f32 v126, v126, s20, -v18
    v_mfma_f32_16x16x32_bf16 v[240:243], v[104:107], v[152:155], v[240:243]
    v_fma_f32 v127, v127, s20, -v18
    v_exp_f32 v120, v120
    v_mfma_f32_16x16x32_bf16 v[244:247], v[108:111], v[136:139], v[244:247]
    v_exp_f32 v121, v121
    v_exp_f32 v122, v122
    v_mfma_f32_16x16x32_bf16 v[248:251], v[108:111], v[144:147], v[248:251]
    v_exp_f32 v123, v123
    v_exp_f32 v124, v124
    v_mfma_f32_16x16x32_bf16 v[252:255], v[108:111], v[152:155], v[252:255]
    v_exp_f32 v125, v125
    ds_read_b128 v[96:99], v5 offset:12288
    ds_read_b128 v[100:103], v6 offset:12288
    ds_read_b128 v[104:107], v7 offset:12288
    ds_read_b128 v[108:111], v8 offset:12288
    s_waitcnt lgkmcnt(4)
    v_mfma_f32_16x16x32_bf16 v[136:139], v[80:83], v[32:35], 0
    v_exp_f32 v126, v126
    v_exp_f32 v127, v127
    v_mfma_f32_16x16x32_bf16 v[144:147], v[80:83], v[48:51], 0
    v_add_f32 v21, v21, v120
    v_add_f32 v21, v21, v121
    v_mfma_f32_16x16x32_bf16 v[152:155], v[80:83], v[64:67], 0
    v_add_f32 v21, v21, v122
    v_add_f32 v21, v21, v123
    v_mfma_f32_16x16x32_bf16 v[136:139], v[84:87], v[36:39], v[136:139]
    v_add_f32 v21, v21, v124
    v_mfma_f32_16x16x32_bf16 v[144:147], v[84:87], v[52:55], v[144:147]
    v_add_f32 v21, v21, v125
    v_add_f32 v21, v21, v126
    v_mfma_f32_16x16x32_bf16 v[152:155], v[84:87], v[68:71], v[152:155]
    v_add_f32 v21, v21, v127
    v_cvt_pk_bf16_f32 v120, v120, v121
    v_mfma_f32_16x16x32_bf16 v[136:139], v[88:91], v[40:43], v[136:139]
    v_cvt_pk_bf16_f32 v121, v122, v123
    v_cvt_pk_bf16_f32 v122, v124, v125
    v_mfma_f32_16x16x32_bf16 v[144:147], v[88:91], v[56:59], v[144:147]
    v_cvt_pk_bf16_f32 v123, v126, v127
    v_mfma_f32_16x16x32_bf16 v[152:155], v[88:91], v[72:75], v[152:155]
    v_fma_f32 v128, v128, s20, -v19
    v_fma_f32 v129, v129, s20, -v19
    v_mfma_f32_16x16x32_bf16 v[136:139], v[92:95], v[44:47], v[136:139]
    v_fma_f32 v130, v130, s20, -v19
    v_fma_f32 v131, v131, s20, -v19
    v_mfma_f32_16x16x32_bf16 v[144:147], v[92:95], v[60:63], v[144:147]
    v_fma_f32 v132, v132, s20, -v19
    v_fma_f32 v133, v133, s20, -v19
    v_mfma_f32_16x16x32_bf16 v[152:155], v[92:95], v[76:79], v[152:155]
    v_fma_f32 v134, v134, s20, -v19
    ds_read_b64_tr_b16 v[80:81], v9 offset:0
    ds_read_b64_tr_b16 v[82:83], v9 offset:4096
    ds_read_b64_tr_b16 v[84:85], v10 offset:0
    ds_read_b64_tr_b16 v[86:87], v10 offset:4096
    ds_read_b64_tr_b16 v[88:89], v11 offset:0
    ds_read_b64_tr_b16 v[90:91], v11 offset:4096
    ds_read_b64_tr_b16 v[92:93], v12 offset:0
    ds_read_b64_tr_b16 v[94:95], v12 offset:4096
    s_waitcnt lgkmcnt(8)
    v_mfma_f32_16x16x32_bf16 v[140:143], v[96:99], v[32:35], 0
    v_fma_f32 v135, v135, s20, -v19
    v_exp_f32 v128, v128
    v_mfma_f32_16x16x32_bf16 v[148:151], v[96:99], v[48:51], 0
    v_exp_f32 v129, v129
    v_exp_f32 v130, v130
    v_mfma_f32_16x16x32_bf16 v[156:159], v[96:99], v[64:67], 0
    v_exp_f32 v131, v131
    v_exp_f32 v132, v132
    v_mfma_f32_16x16x32_bf16 v[140:143], v[100:103], v[36:39], v[140:143]
    v_exp_f32 v133, v133
    v_mfma_f32_16x16x32_bf16 v[148:151], v[100:103], v[52:55], v[148:151]
    v_exp_f32 v134, v134
    v_exp_f32 v135, v135
    v_mfma_f32_16x16x32_bf16 v[156:159], v[100:103], v[68:71], v[156:159]
    v_add_f32 v22, v22, v128
    v_add_f32 v22, v22, v129
    v_mfma_f32_16x16x32_bf16 v[140:143], v[104:107], v[40:43], v[140:143]
    v_add_f32 v22, v22, v130
    v_add_f32 v22, v22, v131
    v_mfma_f32_16x16x32_bf16 v[148:151], v[104:107], v[56:59], v[148:151]
    v_add_f32 v22, v22, v132
    v_mfma_f32_16x16x32_bf16 v[156:159], v[104:107], v[72:75], v[156:159]
    v_add_f32 v22, v22, v133
    v_add_f32 v22, v22, v134
    v_mfma_f32_16x16x32_bf16 v[140:143], v[108:111], v[44:47], v[140:143]
    v_add_f32 v22, v22, v135
    v_cvt_pk_bf16_f32 v128, v128, v129
    v_mfma_f32_16x16x32_bf16 v[148:151], v[108:111], v[60:63], v[148:151]
    v_cvt_pk_bf16_f32 v129, v130, v131
    v_cvt_pk_bf16_f32 v130, v132, v133
    v_mfma_f32_16x16x32_bf16 v[156:159], v[108:111], v[76:79], v[156:159]
    v_cvt_pk_bf16_f32 v131, v134, v135
    ds_read_b64_tr_b16 v[96:97], v13 offset:0
    ds_read_b64_tr_b16 v[98:99], v13 offset:4096
    ds_read_b64_tr_b16 v[100:101], v14 offset:0
    ds_read_b64_tr_b16 v[102:103], v14 offset:4096
    ds_read_b64_tr_b16 v[104:105], v15 offset:0
    ds_read_b64_tr_b16 v[106:107], v15 offset:4096
    ds_read_b64_tr_b16 v[108:109], v16 offset:0
    ds_read_b64_tr_b16 v[110:111], v16 offset:4096
L_ret0:
    s_waitcnt vmcnt(4)
    s_barrier
    v_max3_f32 v23, v136, v137, v138
    v_max3_f32 v23, v23, v139, v140
    v_max3_f32 v23, v23, v141, v142
    v_max_f32 v23, v23, v143
    v_fma_f32 v26, v23, s20, -v17
    v_max3_f32 v24, v144, v145, v146
    v_max3_f32 v24, v24, v147, v148
    v_max3_f32 v24, v24, v149, v150
    v_max_f32 v24, v24, v151
    v_fma_f32 v27, v24, s20, -v18
    v_max3_f32 v25, v152, v153, v154
    v_max3_f32 v25, v25, v155, v156
    v_max3_f32 v25, v25, v157, v158
    v_max_f32 v25, v25, v159
    v_fma_f32 v28, v25, s20, -v19
    v_max3_f32 v26, v26, v27, v28
    v_cmp_lt_f32 vcc, 0x41000000, v26
    s_cbranch_vccnz L_slow1
    s_waitcnt lgkmcnt(8)
    v_mfma_f32_16x16x32_bf16 v[160:163], v[80:83], v[112:115], v[160:163]
    v_fma_f32 v136, v136, s20, -v17
    v_fma_f32 v137, v137, s20, -v17
    v_mfma_f32_16x16x32_bf16 v[164:167], v[80:83], v[120:123], v[164:167]
    v_fma_f32 v138, v138, s20, -v17
    v_fma_f32 v139, v139, s20, -v17
    v_mfma_f32_16x16x32_bf16 v[168:171], v[80:83], v[128:131], v[168:171]
    v_fma_f32 v140, v140, s20, -v17
    v_fma_f32 v141, v141, s20, -v17
    s_mov_b32 m0, s25
    s_nop 0
    buffer_load_dwordx4 v1, s[8:11], s21 offen offset:0 lds
    buffer_load_dwordx4 v2, s[8:11], s21 offen offset:1024 lds
    buffer_load_dwordx4 v3, s[8:11], s21 offen offset:2048 lds
    buffer_load_dwordx4 v4, s[8:11], s21 offen offset:3072 lds
    s_add_u32 s21, s21, 16384
    s_add_u32 s25, s25, s48
    s_cmp_eq_u32 s25, s50
    s_cselect_b32 s25, s43, s25
    v_mfma_f32_16x16x32_bf16 v[172:175], v[84:87], v[112:115], v[172:175]
    v_fma_f32 v142, v142, s20, -v17
    v_mfma_f32_16x16x32_bf16 v[176:179], v[84:87], v[120:123], v[176:179]
    v_fma_f32 v143, v143, s20, -v17
    v_exp_f32 v136, v136
    v_mfma_f32_16x16x32_bf16 v[180:183], v[84:87], v[128:131], v[180:183]
    v_exp_f32 v137, v137
    v_exp_f32 v138, v138
    v_mfma_f32_16x16x32_bf16 v[184:187], v[88:91], v[112:115], v[184:187]
    v_exp_f32 v139, v139
    v_exp_f32 v140, v140
    v_mfma_f32_16x16x32_bf16 v[188:191], v[88:91], v[120:123], v[188:191]
    v_exp_f32 v141, v141
    v_mfma_f32_16x16x32_bf16 v[192:195], v[88:91], v[128:131], v[192:195]
    v_exp_f32 v142, v142
    v_exp_f32 v143, v143
    v_mfma_f32_16x16x32_bf16 v[196:199], v[92:95], v[112:115], v[196:199]
    v_add_f32 v20, v20, v136
    v_add_f32 v20, v20, v137
    v_mfma_f32_16x16x32_bf16 v[200:203], v[92:95], v[120:123], v[200:203]
    v_add_f32 v20, v20, v138
    v_add_f32 v20, v20, v139
    v_mfma_f32_16x16x32_bf16 v[204:207], v[92:95], v[128:131], v[204:207]
    v_add_f32 v20, v20, v140
    ds_read_b128 v[80:83], v5 offset:16384
    ds_read_b128 v[84:87], v6 offset:16384
    ds_read_b128 v[88:91], v7 offset:16384
    ds_read_b128 v[92:95], v8 offset:16384
    s_waitcnt lgkmcnt(4)
    v_mfma_f32_16x16x32_bf16 v[208:211], v[96:99], v[112:115], v[208:211]
    v_add_f32 v20, v20, v141
    v_add_f32 v20, v20, v142
    v_mfma_f32_16x16x32_bf16 v[212:215], v[96:99], v[120:123], v[212:215]
    v_add_f32 v20, v20, v143
    v_cvt_pk_bf16_f32 v136, v136, v137
    v_mfma_f32_16x16x32_bf16 v[216:219], v[96:99], v[128:131], v[216:219]
    v_cvt_pk_bf16_f32 v137, v138, v139
    v_cvt_pk_bf16_f32 v138, v140, v141
    v_mfma_f32_16x16x32_bf16 v[220:223], v[100:103], v[112:115], v[220:223]
    v_cvt_pk_bf16_f32 v139, v142, v143
    v_mfma_f32_16x16x32_bf16 v[224:227], v[100:103], v[120:123], v[224:227]
    v_fma_f32 v144, v144, s20, -v18
    v_fma_f32 v145, v145, s20, -v18
    v_mfma_f32_16x16x32_bf16 v[228:231], v[100:103], v[128:131], v[228:231]
    v_fma_f32 v146, v146, s20, -v18
    v_fma_f32 v147, v147, s20, -v18
    v_mfma_f32_16x16x32_bf16 v[232:235], v[104:107], v[112:115], v[232:235]
    v_fma_f32 v148, v148, s20, -v18
    v_fma_f32 v149, v149, s20, -v18
    v_mfma_f32_16x16x32_bf16 v[236:239], v[104:107], v[120:123], v[236:239]
    v_fma_f32 v150, v150, s20, -v18
    v_mfma_f32_16x16x32_bf16 v[240:243], v[104:107], v[128:131], v[240:243]
    v_fma_f32 v151, v151, s20, -v18
    v_exp_f32 v144, v144
    v_mfma_f32_16x16x32_bf16 v[244:247], v[108:111], v[112:115], v[244:247]
    v_exp_f32 v145, v145
    v_exp_f32 v146, v146
    v_mfma_f32_16x16x32_bf16 v[248:251], v[108:111], v[120:123], v[248:251]
    v_exp_f32 v147, v147
    v_exp_f32 v148, v148
    v_mfma_f32_16x16x32_bf16 v[252:255], v[108:111], v[128:131], v[252:255]
    v_exp_f32 v149, v149
    ds_read_b128 v[96:99], v5 offset:20480
    ds_read_b128 v[100:103], v6 offset:20480
    ds_read_b128 v[104:107], v7 offset:20480
    ds_read_b128 v[108:111], v8 offset:20480
    s_waitcnt lgkmcnt(4)
    v_mfma_f32_16x16x32_bf16 v[112:115], v[80:83], v[32:35], 0
    v_exp_f32 v150, v150
    v_exp_f32 v151, v151
    v_mfma_f32_16x16x32_bf16 v[120:123], v[80:83], v[48:51], 0
    v_add_f32 v21, v21, v144
    v_add_f32 v21, v21, v145
    v_mfma_f32_16x16x32_bf16 v[128:131], v[80:83], v[64:67], 0
    v_add_f32 v21, v21, v146
    v_add_f32 v21, v21, v147
    v_mfma_f32_16x16x32_bf16 v[112:115], v[84:87], v[36:39], v[112:115]
    v_add_f32 v21, v21, v148
    v_mfma_f32_16x16x32_bf16 v[120:123], v[84:87], v[52:55], v[120:123]
    v_add_f32 v21, v21, v149
    v_add_f32 v21, v21, v150
    v_mfma_f32_16x16x32_bf16 v[128:131], v[84:87], v[68:71], v[128:131]
    v_add_f32 v21, v21, v151
    v_cvt_pk_bf16_f32 v144, v144, v145
    v_mfma_f32_16x16x32_bf16 v[112:115], v[88:91], v[40:43], v[112:115]
    v_cvt_pk_bf16_f32 v145, v146, v147
    v_cvt_pk_bf16_f32 v146, v148, v149
    v_mfma_f32_16x16x32_bf16 v[120:123], v[88:91], v[56:59], v[120:123]
    v_cvt_pk_bf16_f32 v147, v150, v151
    v_mfma_f32_16x16x32_bf16 v[128:131], v[88:91], v[72:75], v[128:131]
    v_fma_f32 v152, v152, s20, -v19
    v_fma_f32 v153, v153, s20, -v19
    v_mfma_f32_16x16x32_bf16 v[112:115], v[92:95], v[44:47], v[112:115]
    v_fma_f32 v154, v154, s20, -v19
    v_fma_f32 v155, v155, s20, -v19
    v_mfma_f32_16x16x32_bf16 v[120:123], v[92:95], v[60:63], v[120:123]
    v_fma_f32 v156, v156, s20, -v19
    v_fma_f32 v157, v157, s20, -v19
    v_mfma_f32_16x16x32_bf16 v[128:131], v[92:95], v[76:79], v[128:131]
    v_fma_f32 v158, v158, s20, -v19
    ds_read_b64_tr_b16 v[80:81], v9 offset:16384
    ds_read_b64_tr_b16 v[82:83], v9 offset:20480
    ds_read_b64_tr_b16 v[84:85], v10 offset:16384
    ds_read_b64_tr_b16 v[86:87], v10 offset:20480
    ds_read_b64_tr_b16 v[88:89], v11 offset:16384
    ds_read_b64_tr_b16 v[90:91], v11 offset:20480
    ds_read_b64_tr_b16 v[92:93], v12 offset:16384
    ds_read_b64_tr_b16 v[94:95], v12 offset:20480
    s_waitcnt lgkmcnt(8)
    v_mfma_f32_16x16x32_bf16 v[116:119], v[96:99], v[32:35], 0
    v_fma_f32 v159, v159, s20, -v19
    v_exp_f32 v152, v152
    v_mfma_f32_16x16x32_bf16 v[124:127], v[96:99], v[48:51], 0
    v_exp_f32 v153, v153
    v_exp_f32 v154, v154
    v_mfma_f32_16x16x32_bf16 v[132:135], v[96:99], v[64:67], 0
    v_exp_f32 v155, v155
    v_exp_f32 v156, v156
    v_mfma_f32_16x16x32_bf16 v[116:119], v[100:103], v[36:39], v[116:119]
    v_exp_f32 v157, v157
    v_mfma_f32_16x16x32_bf16 v[124:127], v[100:103], v[52:55], v[124:127]
    v_exp_f32 v158, v158
    v_exp_f32 v159, v159
    v_mfma_f32_16x16x32_bf16 v[132:135], v[100:103], v[68:71], v[132:135]
    v_add_f32 v22, v22, v152
    v_add_f32 v22, v22, v153
    v_mfma_f32_16x16x32_bf16 v[116:119], v[104:107], v[40:43], v[116:119]
    v_add_f32 v22, v22, v154
    v_add_f32 v22, v22, v155
    v_mfma_f32_16x16x32_bf16 v[124:127], v[104:107], v[56:59], v[124:127]
    v_add_f32 v22, v22, v156
    v_mfma_f32_16x16x32_bf16 v[132:135], v[104:107], v[72:75], v[132:135]
    v_add_f32 v22, v22, v157
    v_add_f32 v22, v22, v158
    v_mfma_f32_16x16x32_bf16 v[116:119], v[108:111], v[44:47], v[116:119]
    v_add_f32 v22, v22, v159
    v_cvt_pk_bf16_f32 v152, v152, v153
    v_mfma_f32_16x16x32_bf16 v[124:127], v[108:111], v[60:63], v[124:127]
    v_cvt_pk_bf16_f32 v153, v154, v155
    v_cvt_pk_bf16_f32 v154, v156, v157
    v_mfma_f32_16x16x32_bf16 v[132:135], v[108:111], v[76:79], v[132:135]
    v_cvt_pk_bf16_f32 v155, v158, v159
    ds_read_b64_tr_b16 v[96:97], v13 offset:16384
    ds_read_b64_tr_b16 v[98:99], v13 offset:20480
    ds_read_b64_tr_b16 v[100:101], v14 offset:16384
    ds_read_b64_tr_b16 v[102:103], v14 offset:20480
    ds_read_b64_tr_b16 v[104:105], v15 offset:16384
    ds_read_b64_tr_b16 v[106:107], v15 offset:20480
    ds_read_b64_tr_b16 v[108:109], v16 offset:16384
    ds_read_b64_tr_b16 v[110:111], v16 offset:20480
L_ret1:
    s_waitcnt vmcnt(4)
    s_barrier
    v_max3_f32 v23, v112, v113, v114
    v_max3_f32 v23, v23, v115, v116
    v_max3_f32 v23, v23, v117, v118
    v_max_f32 v23, v23, v119
    v_fma_f32 v26, v23, s20, -v17
    v_max3_f32 v24, v120, v121, v122
    v_max3_f32 v24, v24, v123, v124
    v_max3_f32 v24, v24, v125, v126
    v_max_f32 v24, v24, v127
    v_fma_f32 v27, v24, s20, -v18
    v_max3_f32 v25, v128, v129, v130
    v_max3_f32 v25, v25, v131, v132
    v_max3_f32 v25, v25, v133, v134
    v_max_f32 v25, v25, v135
    v_fma_f32 v28, v25, s20, -v19
    v_max3_f32 v26, v26, v27, v28
    v_cmp_lt_f32 vcc, 0x41000000, v26
    s_cbranch_vccnz L_slow2
    s_waitcnt lgkmcnt(8)
    v_mfma_f32_16x16x32_bf16 v[160:163], v[80:83], v[136:139], v[160:163]
    v_fma_f32 v112, v112, s20, -v17
    v_fma_f32 v113, v113, s20, -v17
    v_mfma_f32_16x16x32_bf16 v[164:167], v[80:83], v[144:147], v[164:167]
    v_fma_f32 v114, v114, s20, -v17
    v_fma_f32 v115, v115, s20, -v17
    v_mfma_f32_16x16x32_bf16 v[168:171], v[80:83], v[152:155], v[168:171]
    v_fma_f32 v116, v116, s20, -v17
    v_fma_f32 v117, v117, s20, -v17
    s_mov_b32 m0, s25
    s_nop 0
    buffer_load_dwordx4 v1, s[8:11], s21 offen offset:0 lds
    buffer_load_dwordx4 v2, s[8:11], s21 offen offset:1024 lds
    buffer_load_dwordx4 v3, s[8:11], s21 offen offset:2048 lds
    buffer_load_dwordx4 v4, s[8:11], s21 offen offset:3072 lds
    s_add_u32 s21, s21, 16384
    s_add_u32 s25, s25, s48
    s_cmp_eq_u32 s25, s50
    s_cselect_b32 s25, s43, s25
    v_mfma_f32_16x16x32_bf16 v[172:175], v[84:87], v[136:139], v[172:175]
    v_fma_f32 v118, v118, s20, -v17
    v_mfma_f32_16x16x32_bf16 v[176:179], v[84:87], v[144:147], v[176:179]
    v_fma_f32 v119, v119, s20, -v17
    v_exp_f32 v112, v112
    v_mfma_f32_16x16x32_bf16 v[180:183], v[84:87], v[152:155], v[180:183]
    v_exp_f32 v113, v113
    v_exp_f32 v114, v114
    v_mfma_f32_16x16x32_bf16 v[184:187], v[88:91], v[136:139], v[184:187]
    v_exp_f32 v115, v115
    v_exp_f32 v116, v116
    v_mfma_f32_16x16x32_bf16 v[188:191], v[88:91], v[144:147], v[188:191]
    v_exp_f32 v117, v117
    v_mfma_f32_16x16x32_bf16 v[192:195], v[88:91], v[152:155], v[192:195]
    v_exp_f32 v118, v118
    v_exp_f32 v119, v119
    v_mfma_f32_16x16x32_bf16 v[196:199], v[92:95], v[136:139], v[196:199]
    v_add_f32 v20, v20, v112
    v_add_f32 v20, v20, v113
    v_mfma_f32_16x16x32_bf16 v[200:203], v[92:95], v[144:147], v[200:203]
    v_add_f32 v20, v20, v114
    v_add_f32 v20, v20, v115
    v_mfma_f32_16x16x32_bf16 v[204:207], v[92:95], v[152:155], v[204:207]
    v_add_f32 v20, v20, v116
    ds_read_b128 v[80:83], v5 offset:24576
    ds_read_b128 v[84:87], v6 offset:24576
    ds_read_b128 v[88:91], v7 offset:24576
    ds_read_b128 v[92:95], v8 offset:24576
    s_waitcnt lgkmcnt(4)
    v_mfma_f32_16x16x32_bf16 v[208:211], v[96:99], v[136:139], v[208:211]
    v_add_f32 v20, v20, v117
    v_add_f32 v20, v20, v118
    v_mfma_f32_16x16x32_bf16 v[212:215], v[96:99], v[144:147], v[212:215]
    v_add_f32 v20, v20, v119
    v_cvt_pk_bf16_f32 v112, v112, v113
    v_mfma_f32_16x16x32_bf16 v[216:219], v[96:99], v[152:155], v[216:219]
    v_cvt_pk_bf16_f32 v113, v114, v115
    v_cvt_pk_bf16_f32 v114, v116, v117
    v_mfma_f32_16x16x32_bf16 v[220:223], v[100:103], v[136:139], v[220:223]
    v_cvt_pk_bf16_f32 v115, v118, v119
    v_mfma_f32_16x16x32_bf16 v[224:227], v[100:103], v[144:147], v[224:227]
    v_fma_f32 v120, v120, s20, -v18
    v_fma_f32 v121, v121, s20, -v18
    v_mfma_f32_16x16x32_bf16 v[228:231], v[100:103], v[152:155], v[228:231]
    v_fma_f32 v122, v122, s20, -v18
    v_fma_f32 v123, v123, s20, -v18
    v_mfma_f32_16x16x32_bf16 v[232:235], v[104:107], v[136:139], v[232:235]
    v_fma_f32 v124, v124, s20, -v18
    v_fma_f32 v125, v125, s20, -v18
    v_mfma_f32_16x16x32_bf16 v[236:239], v[104:107], v[144:147], v[236:239]
    v_fma_f32 v126, v126, s20, -v18
    v_mfma_f32_16x16x32_bf16 v[240:243], v[104:107], v[152:155], v[240:243]
    v_fma_f32 v127, v127, s20, -v18
    v_exp_f32 v120, v120
    v_mfma_f32_16x16x32_bf16 v[244:247], v[108:111], v[136:139], v[244:247]
    v_exp_f32 v121, v121
    v_exp_f32 v122, v122
    v_mfma_f32_16x16x32_bf16 v[248:251], v[108:111], v[144:147], v[248:251]
    v_exp_f32 v123, v123
    v_exp_f32 v124, v124
    v_mfma_f32_16x16x32_bf16 v[252:255], v[108:111], v[152:155], v[252:255]
    v_exp_f32 v125, v125
    ds_read_b128 v[96:99], v5 offset:28672
    ds_read_b128 v[100:103], v6 offset:28672
    ds_read_b128 v[104:107], v7 offset:28672
    ds_read_b128 v[108:111], v8 offset:28672
    s_waitcnt lgkmcnt(4)
    v_mfma_f32_16x16x32_bf16 v[136:139], v[80:83], v[32:35], 0
    v_exp_f32 v126, v126
    v_exp_f32 v127, v127
    v_mfma_f32_16x16x32_bf16 v[144:147], v[80:83], v[48:51], 0
    v_add_f32 v21, v21, v120
    v_add_f32 v21, v21, v121
    v_mfma_f32_16x16x32_bf16 v[152:155], v[80:83], v[64:67], 0
    v_add_f32 v21, v21, v122
    v_add_f32 v21, v21, v123
    v_mfma_f32_16x16x32_bf16 v[136:139], v[84:87], v[36:39], v[136:139]
    v_add_f32 v21, v21, v124
    v_mfma_f32_16x16x32_bf16 v[144:147], v[84:87], v[52:55], v[144:147]
    v_add_f32 v21, v21, v125
    v_add_f32 v21, v21, v126
    v_mfma_f32_16x16x32_bf16 v[152:155], v[84:87], v[68:71], v[152:155]
    v_add_f32 v21, v21, v127
    v_cvt_pk_bf16_f32 v120, v120, v121
    v_mfma_f32_16x16x32_bf16 v[136:139], v[88:91], v[40:43], v[136:139]
    v_cvt_pk_bf16_f32 v121, v122, v123
    v_cvt_pk_bf16_f32 v122, v124, v125
    v_mfma_f32_16x16x32_bf16 v[144:147], v[88:91], v[56:59], v[144:147]
    v_cvt_pk_bf16_f32 v123, v126, v127
    v_mfma_f32_16x16x32_bf16 v[152:155], v[88:91], v[72:75], v[152:155]
    v_fma_f32 v128, v128, s20, -v19
    v_fma_f32 v129, v129, s20, -v19
    v_mfma_f32_16x16x32_bf16 v[136:139], v[92:95], v[44:47], v[136:139]
    v_fma_f32 v130, v130, s20, -v19
    v_fma_f32 v131, v131, s20, -v19
    v_mfma_f32_16x16x32_bf16 v[144:147], v[92:95], v[60:63], v[144:147]
    v_fma_f32 v132, v132, s20, -v19
    v_fma_f32 v133, v133, s20, -v19
    v_mfma_f32_16x16x32_bf16 v[152:155], v[92:95], v[76:79], v[152:155]
    v_fma_f32 v134, v134, s20, -v19
    ds_read_b64_tr_b16 v[80:81], v9 offset:32768
    ds_read_b64_tr_b16 v[82:83], v9 offset:36864
    ds_read_b64_tr_b16 v[84:85], v10 offset:32768
    ds_read_b64_tr_b16 v[86:87], v10 offset:36864
    ds_read_b64_tr_b16 v[88:89], v11 offset:32768
    ds_read_b64_tr_b16 v[90:91], v11 offset:36864
    ds_read_b64_tr_b16 v[92:93], v12 offset:32768
    ds_read_b64_tr_b16 v[94:95], v12 offset:36864
    s_waitcnt lgkmcnt(8)
    v_mfma_f32_16x16x32_bf16 v[140:143], v[96:99], v[32:35], 0
    v_fma_f32 v135, v135, s20, -v19
    v_exp_f32 v128, v128
    v_mfma_f32_16x16x32_bf16 v[148:151], v[96:99], v[48:51], 0
    v_exp_f32 v129, v129
    v_exp_f32 v130, v130
    v_mfma_f32_16x16x32_bf16 v[156:159], v[96:99], v[64:67], 0
    v_exp_f32 v131, v131
    v_exp_f32 v132, v132
    v_mfma_f32_16x16x32_bf16 v[140:143], v[100:103], v[36:39], v[140:143]
    v_exp_f32 v133, v133
    v_mfma_f32_16x16x32_bf16 v[148:151], v[100:103], v[52:55], v[148:151]
    v_exp_f32 v134, v134
    v_exp_f32 v135, v135
    v_mfma_f32_16x16x32_bf16 v[156:159], v[100:103], v[68:71], v[156:159]
    v_add_f32 v22, v22, v128
    v_add_f32 v22, v22, v129
    v_mfma_f32_16x16x32_bf16 v[140:143], v[104:107], v[40:43], v[140:143]
    v_add_f32 v22, v22, v130
    v_add_f32 v22, v22, v131
    v_mfma_f32_16x16x32_bf16 v[148:151], v[104:107], v[56:59], v[148:151]
    v_add_f32 v22, v22, v132
    v_mfma_f32_16x16x32_bf16 v[156:159], v[104:107], v[72:75], v[156:159]
    v_add_f32 v22, v22, v133
    v_add_f32 v22, v22, v134
    v_mfma_f32_16x16x32_bf16 v[140:143], v[108:111], v[44:47], v[140:143]
    v_add_f32 v22, v22, v135
    v_cvt_pk_bf16_f32 v128, v128, v129
    v_mfma_f32_16x16x32_bf16 v[148:151], v[108:111], v[60:63], v[148:151]
    v_cvt_pk_bf16_f32 v129, v130, v131
    v_cvt_pk_bf16_f32 v130, v132, v133
    v_mfma_f32_16x16x32_bf16 v[156:159], v[108:111], v[76:79], v[156:159]
    v_cvt_pk_bf16_f32 v131, v134, v135
    ds_read_b64_tr_b16 v[96:97], v13 offset:32768
    ds_read_b64_tr_b16 v[98:99], v13 offset:36864
    ds_read_b64_tr_b16 v[100:101], v14 offset:32768
    ds_read_b64_tr_b16 v[102:103], v14 offset:36864
    ds_read_b64_tr_b16 v[104:105], v15 offset:32768
    ds_read_b64_tr_b16 v[106:107], v15 offset:36864
    ds_read_b64_tr_b16 v[108:109], v16 offset:32768
    ds_read_b64_tr_b16 v[110:111], v16 offset:36864
L_ret2:
    s_cmp_lg_u32 s26, 0
    s_cbranch_scc1 L_last
    s_waitcnt vmcnt(4)
    s_barrier
    v_max3_f32 v23, v136, v137, v138
    v_max3_f32 v23, v23, v139, v140
    v_max3_f32 v23, v23, v141, v142
    v_max_f32 v23, v23, v143
    v_fma_f32 v26, v23, s20, -v17
    v_max3_f32 v24, v144, v145, v146
    v_max3_f32 v24, v24, v147, v148
    v_max3_f32 v24, v24, v149, v150
    v_max_f32 v24, v24, v151
    v_fma_f32 v27, v24, s20, -v18
    v_max3_f32 v25, v152, v153, v154
    v_max3_f32 v25, v25, v155, v156
    v_max3_f32 v25, v25, v157, v158
    v_max_f32 v25, v25, v159
    v_fma_f32 v28, v25, s20, -v19
    v_max3_f32 v26, v26, v27, v28
    v_cmp_lt_f32 vcc, 0x41000000, v26
    s_cbranch_vccnz L_slow3
    s_waitcnt lgkmcnt(8)
    v_mfma_f32_16x16x32_bf16 v[160:163], v[80:83], v[112:115], v[160:163]
    v_fma_f32 v136, v136, s20, -v17
    v_fma_f32 v137, v137, s20, -v17
    v_mfma_f32_16x16x32_bf16 v[164:167], v[80:83], v[120:123], v[164:167]
    v_fma_f32 v138, v138, s20, -v17
    v_fma_f32 v139, v139, s20, -v17
    v_mfma_f32_16x16x32_bf16 v[168:171], v[80:83], v[128:131], v[168:171]
    v_fma_f32 v140, v140, s20, -v17
    v_fma_f32 v141, v141, s20, -v17
    s_mov_b32 m0, s25
    s_nop 0
    buffer_load_dwordx4 v1, s[8:11], s21 offen offset:0 lds
    buffer_load_dwordx4 v2, s[8:11], s21 offen offset:1024 lds
    buffer_load_dwordx4 v3, s[8:11], s21 offen offset:2048 lds
    buffer_load_dwordx4 v4, s[8:11], s21 offen offset:3072 lds
    s_add_u32 s21, s21, 16384
    s_add_u32 s25, s25, s48
    s_cmp_eq_u32 s25, s50
    s_cselect_b32 s25, s43, s25
    v_mfma_f32_16x16x32_bf16 v[172:175], v[84:87], v[112:115], v[172:175]
    v_fma_f32 v142, v142, s20, -v17
    v_mfma_f32_16x16x32_bf16 v[176:179], v[84:87], v[120:123], v[176:179]
    v_fma_f32 v143, v143, s20, -v17
    v_exp_f32 v136, v136
    v_mfma_f32_16x16x32_bf16 v[180:183], v[84:87], v[128:131], v[180:183]
    v_exp_f32 v137, v137
    v_exp_f32 v138, v138
    v_mfma_f32_16x16x32_bf16 v[184:187], v[88:91], v[112:115], v[184:187]
    v_exp_f32 v139, v139
    v_exp_f32 v140, v140
    v_mfma_f32_16x16x32_bf16 v[188:191], v[88:91], v[120:123], v[188:191]
    v_exp_f32 v141, v141
    v_mfma_f32_16x16x32_bf16 v[192:195], v[88:91], v[128:131], v[192:195]
    v_exp_f32 v142, v142
    v_exp_f32 v143, v143
    v_mfma_f32_16x16x32_bf16 v[196:199], v[92:95], v[112:115], v[196:199]
    v_add_f32 v20, v20, v136
    v_add_f32 v20, v20, v137
    v_mfma_f32_16x16x32_bf16 v[200:203], v[92:95], v[120:123], v[200:203]
    v_add_f32 v20, v20, v138
    v_add_f32 v20, v20, v139
    v_mfma_f32_16x16x32_bf16 v[204:207], v[92:95], v[128:131], v[204:207]
    v_add_f32 v20, v20, v140
    ds_read_b128 v[80:83], v5 offset:0
    ds_read_b128 v[84:87], v6 offset:0
    ds_read_b128 v[88:91], v7 offset:0
    ds_read_b128 v[92:95], v8 offset:0
    s_waitcnt lgkmcnt(4)
    v_mfma_f32_16x16x32_bf16 v[208:211], v[96:99], v[112:115], v[208:211]
    v_add_f32 v20, v20, v141
    v_add_f32 v20, v20, v142
    v_mfma_f32_16x16x32_bf16 v[212:215], v[96:99], v[120:123], v[212:215]
    v_add_f32 v20, v20, v143
    v_cvt_pk_bf16_f32 v136, v136, v137
    v_mfma_f32_16x16x32_bf16 v[216:219], v[96:99], v[128:131], v[216:219]
    v_cvt_pk_bf16_f32 v137, v138, v139
    v_cvt_pk_bf16_f32 v138, v140, v141
    v_mfma_f32_16x16x32_bf16 v[220:223], v[100:103], v[112:115], v[220:223]
    v_cvt_pk_bf16_f32 v139, v142, v143
    v_mfma_f32_16x16x32_bf16 v[224:227], v[100:103], v[120:123], v[224:227]
    v_fma_f32 v144, v144, s20, -v18
    v_fma_f32 v145, v145, s20, -v18
    v_mfma_f32_16x16x32_bf16 v[228:231], v[100:103], v[128:131], v[228:231]
    v_fma_f32 v146, v146, s20, -v18
    v_fma_f32 v147, v147, s20, -v18
    v_mfma_f32_16x16x32_bf16 v[232:235], v[104:107], v[112:115], v[232:235]
    v_fma_f32 v148, v148, s20, -v18
    v_fma_f32 v149, v149, s20, -v18
    v_mfma_f32_16x16x32_bf16 v[236:239], v[104:107], v[120:123], v[236:239]
    v_fma_f32 v150, v150, s20, -v18
    v_mfma_f32_16x16x32_bf16 v[240:243], v[104:107], v[128:131], v[240:243]
    v_fma_f32 v151, v151, s20, -v18
    v_exp_f32 v144, v144
    v_mfma_f32_16x16x32_bf16 v[244:247], v[108:111], v[112:115], v[244:247]
    v_exp_f32 v145, v145
    v_exp_f32 v146, v146
    v_mfma_f32_16x16x32_bf16 v[248:251], v[108:111], v[120:123], v[248:251]
    v_exp_f32 v147, v147
    v_exp_f32 v148, v148
    v_mfma_f32_16x16x32_bf16 v[252:255], v[108:111], v[128:131], v[252:255]
    v_exp_f32 v149, v149
    ds_read_b128 v[96:99], v5 offset:4096
    ds_read_b128 v[100:103], v6 offset:4096
    ds_read_b128 v[104:107], v7 offset:4096
    ds_read_b128 v[108:111], v8 offset:4096
    s_waitcnt lgkmcnt(4)
    v_mfma_f32_16x16x32_bf16 v[112:115], v[80:83], v[32:35], 0
    v_exp_f32 v150, v150
    v_exp_f32 v151, v151
    v_mfma_f32_16x16x32_bf16 v[120:123], v[80:83], v[48:51], 0
    v_add_f32 v21, v21, v144
    v_add_f32 v21, v21, v145
    v_mfma_f32_16x16x32_bf16 v[128:131], v[80:83], v[64:67], 0
    v_add_f32 v21, v21, v146
    v_add_f32 v21, v21, v147
    v_mfma_f32_16x16x32_bf16 v[112:115], v[84:87], v[36:39], v[112:115]
    v_add_f32 v21, v21, v148
    v_mfma_f32_16x16x32_bf16 v[120:123], v[84:87], v[52:55], v[120:123]
    v_add_f32 v21, v21, v149
    v_add_f32 v21, v21, v150
    v_mfma_f32_16x16x32_bf16 v[128:131], v[84:87], v[68:71], v[128:131]
    v_add_f32 v21, v21, v151
    v_cvt_pk_bf16_f32 v144, v144, v145
    v_mfma_f32_16x16x32_bf16 v[112:115], v[88:91], v[40:43], v[112:115]
    v_cvt_pk_bf16_f32 v145, v146, v147
    v_cvt_pk_bf16_f32 v146, v148, v149
    v_mfma_f32_16x16x32_bf16 v[120:123], v[88:91], v[56:59], v[120:123]
    v_cvt_pk_bf16_f32 v147, v150, v151
    v_mfma_f32_16x16x32_bf16 v[128:131], v[88:91], v[72:75], v[128:131]
    v_fma_f32 v152, v152, s20, -v19
    v_fma_f32 v153, v153, s20, -v19
    v_mfma_f32_16x16x32_bf16 v[112:115], v[92:95], v[44:47], v[112:115]
    v_fma_f32 v154, v154, s20, -v19
    v_fma_f32 v155, v155, s20, -v19
    v_mfma_f32_16x16x32_bf16 v[120:123], v[92:95], v[60:63], v[120:123]
    v_fma_f32 v156, v156, s20, -v19
    v_fma_f32 v157, v157, s20, -v19
    v_mfma_f32_16x16x32_bf16 v[128:131], v[92:95], v[76:79], v[128:131]
    v_fma_f32 v158, v158, s20, -v19
    ds_read_b64_tr_b16 v[80:81], v9 offset:49152
    ds_read_b64_tr_b16 v[82:83], v9 offset:53248
    ds_read_b64_tr_b16 v[84:85], v10 offset:49152
    ds_read_b64_tr_b16 v[86:87], v10 offset:53248
    ds_read_b64_tr_b16 v[88:89], v11 offset:49152
    ds_read_b64_tr_b16 v[90:91], v11 offset:53248
    ds_read_b64_tr_b16 v[92:93], v12 offset:49152
    ds_read_b64_tr_b16 v[94:95], v12 offset:53248
    s_waitcnt lgkmcnt(8)
    v_mfma_f32_16x16x32_bf16 v[116:119], v[96:99], v[32:35], 0
    v_fma_f32 v159, v159, s20, -v19
    v_exp_f32 v152, v152
    v_mfma_f32_16x16x32_bf16 v[124:127], v[96:99], v[48:51], 0
    v_exp_f32 v153, v153
    v_exp_f32 v154, v154
    v_mfma_f32_16x16x32_bf16 v[132:135], v[96:99], v[64:67], 0
    v_exp_f32 v155, v155
    v_exp_f32 v156, v156
    v_mfma_f32_16x16x32_bf16 v[116:119], v[100:103], v[36:39], v[116:119]
    v_exp_f32 v157, v157
    v_mfma_f32_16x16x32_bf16 v[124:127], v[100:103], v[52:55], v[124:127]
    v_exp_f32 v158, v158
    v_exp_f32 v159, v159
    v_mfma_f32_16x16x32_bf16 v[132:135], v[100:103], v[68:71], v[132:135]
    v_add_f32 v22, v22, v152
    v_add_f32 v22, v22, v153
    v_mfma_f32_16x16x32_bf16 v[116:119], v[104:107], v[40:43], v[116:119]
    v_add_f32 v22, v22, v154
    v_add_f32 v22, v22, v155
    v_mfma_f32_16x16x32_bf16 v[124:127], v[104:107], v[56:59], v[124:127]
    v_add_f32 v22, v22, v156
    v_mfma_f32_16x16x32_bf16 v[132:135], v[104:107], v[72:75], v[132:135]
    v_add_f32 v22, v22, v157
    v_add_f32 v22, v22, v158
    v_mfma_f32_16x16x32_bf16 v[116:119], v[108:111], v[44:47], v[116:119]
    v_add_f32 v22, v22, v159
    v_cvt_pk_bf16_f32 v152, v152, v153
    v_mfma_f32_16x16x32_bf16 v[124:127], v[108:111], v[60:63], v[124:127]
    v_cvt_pk_bf16_f32 v153, v154, v155
    v_cvt_pk_bf16_f32 v154, v156, v157
    v_mfma_f32_16x16x32_bf16 v[132:135], v[108:111], v[76:79], v[132:135]
    v_cvt_pk_bf16_f32 v155, v158, v159
    ds_read_b64_tr_b16 v[96:97], v13 offset:49152
    ds_read_b64_tr_b16 v[98:99], v13 offset:53248
    ds_read_b64_tr_b16 v[100:101], v14 offset:49152
    ds_read_b64_tr_b16 v[102:103], v14 offset:53248
    ds_read_b64_tr_b16 v[104:105], v15 offset:49152
    ds_read_b64_tr_b16 v[106:107], v15 offset:53248
    ds_read_b64_tr_b16 v[108:109], v16 offset:49152
    ds_read_b64_tr_b16 v[110:111], v16 offset:53248
L_ret3:
    s_mov_b32 s26, 4
    s_branch L_loop
L_last:
    s_waitcnt vmcnt(4)
    s_barrier
    v_max3_f32 v23, v136, v137, v138
    v_max3_f32 v23, v23, v139, v140
    v_max3_f32 v23, v23, v141, v142
    v_max_f32 v23, v23, v143
    v_fma_f32 v26, v23, s20, -v17
    v_max3_f32 v24, v144, v145, v146
    v_max3_f32 v24, v24, v147, v148
    v_max3_f32 v24, v24, v149, v150
    v_max_f32 v24, v24, v151
    v_fma_f32 v27, v24, s20, -v18
    v_max3_f32 v25, v152, v153, v154
    v_max3_f32 v25, v25, v155, v156
    v_max3_f32 v25, v25, v157, v158
    v_max_f32 v25, v25, v159
    v_fma_f32 v28, v25, s20, -v19
    v_max3_f32 v26, v26, v27, v28
    v_cmp_lt_f32 vcc, 0x41000000, v26
    s_cbranch_vccnz L_slow3l
    s_waitcnt lgkmcnt(8)
    v_mfma_f32_16x16x32_bf16 v[160:163], v[80:83], v[112:115], v[160:163]
    v_fma_f32 v136, v136, s20, -v17
    v_fma_f32 v137, v137, s20, -v17
    v_fma_f32 v138, v138, s20, -v17
    v_fma_f32 v139, v139, s20, -v17
    v_mfma_f32_16x16x32_bf16 v[164:167], v[80:83], v[120:123], v[164:167]
    v_fma_f32 v140, v140, s20, -v17
    v_fma_f32 v141, v141, s20, -v17
    v_fma_f32 v142, v142, s20, -v17
    v_mfma_f32_16x16x32_bf16 v[168:171], v[80:83], v[128:131], v[168:171]
    v_fma_f32 v143, v143, s20, -v17
    v_exp_f32 v136, v136
    v_exp_f32 v137, v137
    v_exp_f32 v138, v138
    v_mfma_f32_16x16x32_bf16 v[172:175], v[84:87], v[112:115], v[172:175]
    v_exp_f32 v139, v139
    v_exp_f32 v140, v140
    v_exp_f32 v141, v141
    v_mfma_f32_16x16x32_bf16 v[176:179], v[84:87], v[120:123], v[176:179]
    v_exp_f32 v142, v142
    v_exp_f32 v143, v143
    v_add_f32 v20, v20, v136
    v_add_f32 v20, v20, v137
    v_mfma_f32_16x16x32_bf16 v[180:183], v[84:87], v[128:131], v[180:183]
    v_add_f32 v20, v20, v138
    v_add_f32 v20, v20, v139
    v_add_f32 v20, v20, v140
    v_mfma_f32_16x16x32_bf16 v[184:187], v[88:91], v[112:115], v[184:187]
    v_add_f32 v20, v20, v141
    v_add_f32 v20, v20, v142
    v_add_f32 v20, v20, v143
    v_cvt_pk_bf16_f32 v136, v136, v137
    v_mfma_f32_16x16x32_bf16 v[188:191], v[88:91], v[120:123], v[188:191]
    v_cvt_pk_bf16_f32 v137, v138, v139
    v_cvt_pk_bf16_f32 v138, v140, v141
    v_cvt_pk_bf16_f32 v139, v142, v143
    v_mfma_f32_16x16x32_bf16 v[192:195], v[88:91], v[128:131], v[192:195]
    v_fma_f32 v144, v144, s20, -v18
    v_fma_f32 v145, v145, s20, -v18
    v_fma_f32 v146, v146, s20, -v18
    v_fma_f32 v147, v147, s20, -v18
    v_mfma_f32_16x16x32_bf16 v[196:199], v[92:95], v[112:115], v[196:199]
    v_fma_f32 v148, v148, s20, -v18
    v_fma_f32 v149, v149, s20, -v18
    v_fma_f32 v150, v150, s20, -v18
    v_mfma_f32_16x16x32_bf16 v[200:203], v[92:95], v[120:123], v[200:203]
    v_fma_f32 v151, v151, s20, -v18
    v_exp_f32 v144, v144
    v_exp_f32 v145, v145
    v_exp_f32 v146, v146
    v_mfma_f32_16x16x32_bf16 v[204:207], v[92:95], v[128:131], v[204:207]
    v_exp_f32 v147, v147
    v_exp_f32 v148, v148
    v_exp_f32 v149, v149
    s_waitcnt lgkmcnt(0)
    v_mfma_f32_16x16x32_bf16 v[208:211], v[96:99], v[112:115], v[208:211]
    v_exp_f32 v150, v150
    v_exp_f32 v151, v151
    v_add_f32 v21, v21, v144
    v_add_f32 v21, v21, v145
    v_mfma_f32_16x16x32_bf16 v[212:215], v[96:99], v[120:123], v[212:215]
    v_add_f32 v21, v21, v146
    v_add_f32 v21, v21, v147
    v_add_f32 v21, v21, v148
    v_mfma_f32_16x16x32_bf16 v[216:219], v[96:99], v[128:131], v[216:219]
    v_add_f32 v21, v21, v149
    v_add_f32 v21, v21, v150
    v_add_f32 v21, v21, v151
    v_cvt_pk_bf16_f32 v144, v144, v145
    v_mfma_f32_16x16x32_bf16 v[220:223], v[100:103], v[112:115], v[220:223]
    v_cvt_pk_bf16_f32 v145, v146, v147
    v_cvt_pk_bf16_f32 v146, v148, v149
    v_cvt_pk_bf16_f32 v147, v150, v151
    v_mfma_f32_16x16x32_bf16 v[224:227], v[100:103], v[120:123], v[224:227]
    v_fma_f32 v152, v152, s20, -v19
    v_fma_f32 v153, v153, s20, -v19
    v_fma_f32 v154, v154, s20, -v19
    v_fma_f32 v155, v155, s20, -v19
    v_mfma_f32_16x16x32_bf16 v[228:231], v[100:103], v[128:131], v[228:231]
    v_fma_f32 v156, v156, s20, -v19
    v_fma_f32 v157, v157, s20, -v19
    v_fma_f32 v158, v158, s20, -v19
    v_mfma_f32_16x16x32_bf16 v[232:235], v[104:107], v[112:115], v[232:235]
    v_fma_f32 v159, v159, s20, -v19
    v_exp_f32 v152, v152
    v_exp_f32 v153, v153
    v_exp_f32 v154, v154
    v_mfma_f32_16x16x32_bf16 v[236:239], v[104:107], v[120:123], v[236:239]
    v_exp_f32 v155, v155
    v_exp_f32 v156, v156
    v_exp_f32 v157, v157
    v_mfma_f32_16x16x32_bf16 v[240:243], v[104:107], v[128:131], v[240:243]
    v_exp_f32 v158, v158
    v_exp_f32 v159, v159
    v_add_f32 v22, v22, v152
    v_add_f32 v22, v22, v153
    v_mfma_f32_16x16x32_bf16 v[244:247], v[108:111], v[112:115], v[244:247]
    v_add_f32 v22, v22, v154
    v_add_f32 v22, v22, v155
    v_add_f32 v22, v22, v156
    v_mfma_f32_16x16x32_bf16 v[248:251], v[108:111], v[120:123], v[248:251]
    v_add_f32 v22, v22, v157
    v_add_f32 v22, v22, v158
    v_add_f32 v22, v22, v159
    v_cvt_pk_bf16_f32 v152, v152, v153
    v_mfma_f32_16x16x32_bf16 v[252:255], v[108:111], v[128:131], v[252:255]
    v_cvt_pk_bf16_f32 v153, v154, v155
    v_cvt_pk_bf16_f32 v154, v156, v157
    v_cvt_pk_bf16_f32 v155, v158, v159
    ds_read_b64_tr_b16 v[80:81], v9 offset:49152
    ds_read_b64_tr_b16 v[82:83], v9 offset:53248
    ds_read_b64_tr_b16 v[84:85], v10 offset:49152
    ds_read_b64_tr_b16 v[86:87], v10 offset:53248
    ds_read_b64_tr_b16 v[88:89], v11 offset:49152
    ds_read_b64_tr_b16 v[90:91], v11 offset:53248
    ds_read_b64_tr_b16 v[92:93], v12 offset:49152
    ds_read_b64_tr_b16 v[94:95], v12 offset:53248
    ds_read_b64_tr_b16 v[96:97], v13 offset:49152
    ds_read_b64_tr_b16 v[98:99], v13 offset:53248
    ds_read_b64_tr_b16 v[100:101], v14 offset:49152
    ds_read_b64_tr_b16 v[102:103], v14 offset:53248
    ds_read_b64_tr_b16 v[104:105], v15 offset:49152
    ds_read_b64_tr_b16 v[106:107], v15 offset:53248
    ds_read_b64_tr_b16 v[108:109], v16 offset:49152
    ds_read_b64_tr_b16 v[110:111], v16 offset:53248
L_ret3l:
    s_waitcnt lgkmcnt(0)
    v_mfma_f32_16x16x32_bf16 v[160:163], v[80:83], v[136:139], v[160:163]
    v_mfma_f32_16x16x32_bf16 v[164:167], v[80:83], v[144:147], v[164:167]
    v_mfma_f32_16x16x32_bf16 v[168:171], v[80:83], v[152:155], v[168:171]
    v_mfma_f32_16x16x32_bf16 v[172:175], v[84:87], v[136:139], v[172:175]
    v_mfma_f32_16x16x32_bf16 v[176:179], v[84:87], v[144:147], v[176:179]
    v_mfma_f32_16x16x32_bf16 v[180:183], v[84:87], v[152:155], v[180:183]
    v_mfma_f32_16x16x32_bf16 v[184:187], v[88:91], v[136:139], v[184:187]
    v_mfma_f32_16x16x32_bf16 v[188:191], v[88:91], v[144:147], v[188:191]
    v_mfma_f32_16x16x32_bf16 v[192:195], v[88:91], v[152:155], v[192:195]
    v_mfma_f32_16x16x32_bf16 v[196:199], v[92:95], v[136:139], v[196:199]
    v_mfma_f32_16x16x32_bf16 v[200:203], v[92:95], v[144:147], v[200:203]
    v_mfma_f32_16x16x32_bf16 v[204:207], v[92:95], v[152:155], v[204:207]
    v_mfma_f32_16x16x32_bf16 v[208:211], v[96:99], v[136:139], v[208:211]
    v_mfma_f32_16x16x32_bf16 v[212:215], v[96:99], v[144:147], v[212:215]
    v_mfma_f32_16x16x32_bf16 v[216:219], v[96:99], v[152:155], v[216:219]
    v_mfma_f32_16x16x32_bf16 v[220:223], v[100:103], v[136:139], v[220:223]
    v_mfma_f32_16x16x32_bf16 v[224:227], v[100:103], v[144:147], v[224:227]
    v_mfma_f32_16x16x32_bf16 v[228:231], v[100:103], v[152:155], v[228:231]
    v_mfma_f32_16x16x32_bf16 v[232:235], v[104:107], v[136:139], v[232:235]
    v_mfma_f32_16x16x32_bf16 v[236:239], v[104:107], v[144:147], v[236:239]
    v_mfma_f32_16x16x32_bf16 v[240:243], v[104:107], v[152:155], v[240:243]
    v_mfma_f32_16x16x32_bf16 v[244:247], v[108:111], v[136:139], v[244:247]
    v_mfma_f32_16x16x32_bf16 v[248:251], v[108:111], v[144:147], v[248:251]
    v_mfma_f32_16x16x32_bf16 v[252:255], v[108:111], v[152:155], v[252:255]
    s_branch L_epi
L_slow0:
    s_waitcnt lgkmcnt(0)
    v_mfma_f32_16x16x32_bf16 v[160:163], v[80:83], v[136:139], v[160:163]
    v_mfma_f32_16x16x32_bf16 v[164:167], v[80:83], v[144:147], v[164:167]
    v_mfma_f32_16x16x32_bf16 v[168:171], v[80:83], v[152:155], v[168:171]
    v_mfma_f32_16x16x32_bf16 v[172:175], v[84:87], v[136:139], v[172:175]
    v_mfma_f32_16x16x32_bf16 v[176:179], v[84:87], v[144:147], v[176:179]
    v_mfma_f32_16x16x32_bf16 v[180:183], v[84:87], v[152:155], v[180:183]
    v_mfma_f32_16x16x32_bf16 v[184:187], v[88:91], v[136:139], v[184:187]
    v_mfma_f32_16x16x32_bf16 v[188:191], v[88:91], v[144:147], v[188:191]
    v_mfma_f32_16x16x32_bf16 v[192:195], v[88:91], v[152:155], v[192:195]
    v_mfma_f32_16x16x32_bf16 v[196:199], v[92:95], v[136:139], v[196:199]
    v_mfma_f32_16x16x32_bf16 v[200:203], v[92:95], v[144:147], v[200:203]
    v_mfma_f32_16x16x32_bf16 v[204:207], v[92:95], v[152:155], v[204:207]
    v_mfma_f32_16x16x32_bf16 v[208:211], v[96:99], v[136:139], v[208:211]
    v_mfma_f32_16x16x32_bf16 v[212:215], v[96:99], v[144:147], v[212:215]
    v_mfma_f32_16x16x32_bf16 v[216:219], v[96:99], v[152:155], v[216:219]
    v_mfma_f32_16x16x32_bf16 v[220:223], v[100:103], v[136:139], v[220:223]
    v_mfma_f32_16x16x32_bf16 v[224:227], v[100:103], v[144:147], v[224:227]
    v_mfma_f32_16x16x32_bf16 v[228:231], v[100:103], v[152:155], v[228:231]
    v_mfma_f32_16x16x32_bf16 v[232:235], v[104:107], v[136:139], v[232:235]
    v_mfma_f32_16x16x32_bf16 v[236:239], v[104:107], v[144:147], v[236:239]
    v_mfma_f32_16x16x32_bf16 v[240:243], v[104:107], v[152:155], v[240:243]
    v_mfma_f32_16x16x32_bf16 v[244:247], v[108:111], v[136:139], v[244:247]
    v_mfma_f32_16x16x32_bf16 v[248:251], v[108:111], v[144:147], v[248:251]
    v_mfma_f32_16x16x32_bf16 v[252:255], v[108:111], v[152:155], v[252:255]
    s_mov_b32 m0, s25
    s_nop 0
    buffer_load_dwordx4 v1, s[8:11], s21 offen offset:0 lds
    buffer_load_dwordx4 v2, s[8:11], s21 offen offset:1024 lds
    buffer_load_dwordx4 v3, s[8:11], s21 offen offset:2048 lds
    buffer_load_dwordx4 v4, s[8:11], s21 offen offset:3072 lds
    s_add_u32 s21, s21, 16384
    s_add_u32 s25, s25, s48
    s_cmp_eq_u32 s25, s50
    s_cselect_b32 s25, s43, s25
    ds_read_b128 v[80:83], v5 offset:8192
    ds_read_b128 v[84:87], v6 offset:8192
    ds_read_b128 v[88:91], v7 offset:8192
    ds_read_b128 v[92:95], v8 offset:8192
    ds_read_b128 v[96:99], v5 offset:12288
    ds_read_b128 v[100:103], v6 offset:12288
    ds_read_b128 v[104:107], v7 offset:12288
    ds_read_b128 v[108:111], v8 offset:12288
    s_nop 7
    v_mov_b32 v29, v23
    s_nop 1
    v_permlane32_swap_b32 v23, v29
    s_nop 1
    v_max_f32 v23, v23, v29
    v_mov_b32 v29, v23
    s_nop 1
    v_permlane16_swap_b32 v23, v29
    s_nop 1
    v_max_f32 v23, v23, v29
    v_mul_f32 v23, s20, v23
    v_max_f32 v23, v23, v17
    v_sub_f32 v29, v17, v23
    v_exp_f32 v29, v29
    v_mov_b32 v17, v23
    v_mul_f32 v20, v20, v29
    v_mul_f32 v160, v160, v29
    v_mul_f32 v161, v161, v29
    v_mul_f32 v162, v162, v29
    v_mul_f32 v163, v163, v29
    v_mul_f32 v172, v172, v29
    v_mul_f32 v173, v173, v29
    v_mul_f32 v174, v174, v29
    v_mul_f32 v175, v175, v29
    v_mul_f32 v184, v184, v29
    v_mul_f32 v185, v185, v29
    v_mul_f32 v186, v186, v29
    v_mul_f32 v187, v187, v29
    v_mul_f32 v196, v196, v29
    v_mul_f32 v197, v197, v29
    v_mul_f32 v198, v198, v29
    v_mul_f32 v199, v199, v29
    v_mul_f32 v208, v208, v29
    v_mul_f32 v209, v209, v29
    v_mul_f32 v210, v210, v29
    v_mul_f32 v211, v211, v29
    v_mul_f32 v220, v220, v29
    v_mul_f32 v221, v221, v29
    v_mul_f32 v222, v222, v29
    v_mul_f32 v223, v223, v29
    v_mul_f32 v232, v232, v29
    v_mul_f32 v233, v233, v29
    v_mul_f32 v234, v234, v29
    v_mul_f32 v235, v235, v29
    v_mul_f32 v244, v244, v29
    v_mul_f32 v245, v245, v29
    v_mul_f32 v246, v246, v29
    v_mul_f32 v247, v247, v29
    v_mov_b32 v29, v24
    s_nop 1
    v_permlane32_swap_b32 v24, v29
    s_nop 1
    v_max_f32 v24, v24, v29
    v_mov_b32 v29, v24
    s_nop 1
    v_permlane16_swap_b32 v24, v29
    s_nop 1
    v_max_f32 v24, v24, v29
    v_mul_f32 v24, s20, v24
    v_max_f32 v24, v24, v18
    v_sub_f32 v29, v18, v24
    v_exp_f32 v29, v29
    v_mov_b32 v18, v24
    v_mul_f32 v21, v21, v29
    v_mul_f32 v164, v164, v29
    v_mul_f32 v165, v165, v29
    v_mul_f32 v166, v166, v29
    v_mul_f32 v167, v167, v29
    v_mul_f32 v176, v176, v29
    v_mul_f32 v177, v177, v29
    v_mul_f32 v178, v178, v29
    v_mul_f32 v179, v179, v29
    v_mul_f32 v188, v188, v29
    v_mul_f32 v189, v189, v29
    v_mul_f32 v190, v190, v29
    v_mul_f32 v191, v191, v29
    v_mul_f32 v200, v200, v29
    v_mul_f32 v201, v201, v29
    v_mul_f32 v202, v202, v29
    v_mul_f32 v203, v203, v29
    v_mul_f32 v212, v212, v29
    v_mul_f32 v213, v213, v29
    v_mul_f32 v214, v214, v29
    v_mul_f32 v215, v215, v29
    v_mul_f32 v224, v224, v29
    v_mul_f32 v225, v225, v29
    v_mul_f32 v226, v226, v29
    v_mul_f32 v227, v227, v29
    v_mul_f32 v236, v236, v29
    v_mul_f32 v237, v237, v29
    v_mul_f32 v238, v238, v29
    v_mul_f32 v239, v239, v29
    v_mul_f32 v248, v248, v29
    v_mul_f32 v249, v249, v29
    v_mul_f32 v250, v250, v29
    v_mul_f32 v251, v251, v29
    v_mov_b32 v29, v25
    s_nop 1
    v_permlane32_swap_b32 v25, v29
    s_nop 1
    v_max_f32 v25, v25, v29
    v_mov_b32 v29, v25
    s_nop 1
    v_permlane16_swap_b32 v25, v29
    s_nop 1
    v_max_f32 v25, v25, v29
    v_mul_f32 v25, s20, v25
    v_max_f32 v25, v25, v19
    v_sub_f32 v29, v19, v25
    v_exp_f32 v29, v29
    v_mov_b32 v19, v25
    v_mul_f32 v22, v22, v29
    v_mul_f32 v168, v168, v29
    v_mul_f32 v169, v169, v29
    v_mul_f32 v170, v170, v29
    v_mul_f32 v171, v171, v29
    v_mul_f32 v180, v180, v29
    v_mul_f32 v181, v181, v29
    v_mul_f32 v182, v182, v29
    v_mul_f32 v183, v183, v29
    v_mul_f32 v192, v192, v29
    v_mul_f32 v193, v193, v29
    v_mul_f32 v194, v194, v29
    v_mul_f32 v195, v195, v29
    v_mul_f32 v204, v204, v29
    v_mul_f32 v205, v205, v29
    v_mul_f32 v206, v206, v29
    v_mul_f32 v207, v207, v29
    v_mul_f32 v216, v216, v29
    v_mul_f32 v217, v217, v29
    v_mul_f32 v218, v218, v29
    v_mul_f32 v219, v219, v29
    v_mul_f32 v228, v228, v29
    v_mul_f32 v229, v229, v29
    v_mul_f32 v230, v230, v29
    v_mul_f32 v231, v231, v29
    v_mul_f32 v240, v240, v29
    v_mul_f32 v241, v241, v29
    v_mul_f32 v242, v242, v29
    v_mul_f32 v243, v243, v29
    v_mul_f32 v252, v252, v29
    v_mul_f32 v253, v253, v29
    v_mul_f32 v254, v254, v29
    v_mul_f32 v255, v255, v29
    s_waitcnt lgkmcnt(0)
    v_mfma_f32_16x16x32_bf16 v[136:139], v[80:83], v[32:35], 0
    v_mfma_f32_16x16x32_bf16 v[144:147], v[80:83], v[48:51], 0
    v_mfma_f32_16x16x32_bf16 v[152:155], v[80:83], v[64:67], 0
    v_mfma_f32_16x16x32_bf16 v[136:139], v[84:87], v[36:39], v[136:139]
    v_mfma_f32_16x16x32_bf16 v[144:147], v[84:87], v[52:55], v[144:147]
    v_mfma_f32_16x16x32_bf16 v[152:155], v[84:87], v[68:71], v[152:155]
    v_mfma_f32_16x16x32_bf16 v[136:139], v[88:91], v[40:43], v[136:139]
    v_mfma_f32_16x16x32_bf16 v[144:147], v[88:91], v[56:59], v[144:147]
    v_mfma_f32_16x16x32_bf16 v[152:155], v[88:91], v[72:75], v[152:155]
    v_mfma_f32_16x16x32_bf16 v[136:139], v[92:95], v[44:47], v[136:139]
    v_mfma_f32_16x16x32_bf16 v[144:147], v[92:95], v[60:63], v[144:147]
    v_mfma_f32_16x16x32_bf16 v[152:155], v[92:95], v[76:79], v[152:155]
    v_mfma_f32_16x16x32_bf16 v[140:143], v[96:99], v[32:35], 0
    v_mfma_f32_16x16x32_bf16 v[148:151], v[96:99], v[48:51], 0
    v_mfma_f32_16x16x32_bf16 v[156:159], v[96:99], v[64:67], 0
    v_mfma_f32_16x16x32_bf16 v[140:143], v[100:103], v[36:39], v[140:143]
    v_mfma_f32_16x16x32_bf16 v[148:151], v[100:103], v[52:55], v[148:151]
    v_mfma_f32_16x16x32_bf16 v[156:159], v[100:103], v[68:71], v[156:159]
    v_mfma_f32_16x16x32_bf16 v[140:143], v[104:107], v[40:43], v[140:143]
    v_mfma_f32_16x16x32_bf16 v[148:151], v[104:107], v[56:59], v[148:151]
    v_mfma_f32_16x16x32_bf16 v[156:159], v[104:107], v[72:75], v[156:159]
    v_mfma_f32_16x16x32_bf16 v[140:143], v[108:111], v[44:47], v[140:143]
    v_mfma_f32_16x16x32_bf16 v[148:151], v[108:111], v[60:63], v[148:151]
    v_mfma_f32_16x16x32_bf16 v[156:159], v[108:111], v[76:79], v[156:159]
    ds_read_b64_tr_b16 v[80:81], v9 offset:0
    ds_read_b64_tr_b16 v[82:83], v9 offset:4096
    ds_read_b64_tr_b16 v[84:85], v10 offset:0
    ds_read_b64_tr_b16 v[86:87], v10 offset:4096
    ds_read_b64_tr_b16 v[88:89], v11 offset:0
    ds_read_b64_tr_b16 v[90:91], v11 offset:4096
    ds_read_b64_tr_b16 v[92:93], v12 offset:0
    ds_read_b64_tr_b16 v[94:95], v12 offset:4096
    ds_read_b64_tr_b16 v[96:97], v13 offset:0
    ds_read_b64_tr_b16 v[98:99], v13 offset:4096
    ds_read_b64_tr_b16 v[100:101], v14 offset:0
    ds_read_b64_tr_b16 v[102:103], v14 offset:4096
    ds_read_b64_tr_b16 v[104:105], v15 offset:0
    ds_read_b64_tr_b16 v[106:107], v15 offset:4096
    ds_read_b64_tr_b16 v[108:109], v16 offset:0
    ds_read_b64_tr_b16 v[110:111], v16 offset:4096
    v_fma_f32 v112, v112, s20, -v17
    v_fma_f32 v113, v113, s20, -v17
    v_fma_f32 v114, v114, s20, -v17
    v_fma_f32 v115, v115, s20, -v17
    v_fma_f32 v116, v116, s20, -v17
    v_fma_f32 v117, v117, s20, -v17
    v_fma_f32 v118, v118, s20, -v17
    v_fma_f32 v119, v119, s20, -v17
    v_exp_f32 v112, v112
    v_exp_f32 v113, v113
    v_exp_f32 v114, v114
    v_exp_f32 v115, v115
    v_exp_f32 v116, v116
    v_exp_f32 v117, v117
    v_exp_f32 v118, v118
    v_exp_f32 v119, v119
    v_add_f32 v20, v20, v112
    v_add_f32 v20, v20, v113
    v_add_f32 v20, v20, v114
    v_add_f32 v20, v20, v115
    v_add_f32 v20, v20, v116
    v_add_f32 v20, v20, v117
    v_add_f32 v20, v20, v118
    v_add_f32 v20, v20, v119
    v_cvt_pk_bf16_f32 v112, v112, v113
    v_cvt_pk_bf16_f32 v113, v114, v115
    v_cvt_pk_bf16_f32 v114, v116, v117
    v_cvt_pk_bf16_f32 v115, v118, v119
    v_fma_f32 v120, v120, s20, -v18
    v_fma_f32 v121, v121, s20, -v18
    v_fma_f32 v122, v122, s20, -v18
    v_fma_f32 v123, v123, s20, -v18
    v_fma_f32 v124, v124, s20, -v18
    v_fma_f32 v125, v125, s20, -v18
    v_fma_f32 v126, v126, s20, -v18
    v_fma_f32 v127, v127, s20, -v18
    v_exp_f32 v120, v120
    v_exp_f32 v121, v121
    v_exp_f32 v122, v122
    v_exp_f32 v123, v123
    v_exp_f32 v124, v124
    v_exp_f32 v125, v125
    v_exp_f32 v126, v126
    v_exp_f32 v127, v127
    v_add_f32 v21, v21, v120
    v_add_f32 v21, v21, v121
    v_add_f32 v21, v21, v122
    v_add_f32 v21, v21, v123
    v_add_f32 v21, v21, v124
    v_add_f32 v21, v21, v125
    v_add_f32 v21, v21, v126
    v_add_f32 v21, v21, v127
    v_cvt_pk_bf16_f32 v120, v120, v121
    v_cvt_pk_bf16_f32 v121, v122, v123
    v_cvt_pk_bf16_f32 v122, v124, v125
    v_cvt_pk_bf16_f32 v123, v126, v127
    v_fma_f32 v128, v128, s20, -v19
    v_fma_f32 v129, v129, s20, -v19
    v_fma_f32 v130, v130, s20, -v19
    v_fma_f32 v131, v131, s20, -v19
    v_fma_f32 v132, v132, s20, -v19
    v_fma_f32 v133, v133, s20, -v19
    v_fma_f32 v134, v134, s20, -v19
    v_fma_f32 v135, v135, s20, -v19
    v_exp_f32 v128, v128
    v_exp_f32 v129, v129
    v_exp_f32 v130, v130
    v_exp_f32 v131, v131
    v_exp_f32 v132, v132
    v_exp_f32 v133, v133
    v_exp_f32 v134, v134
    v_exp_f32 v135, v135
    v_add_f32 v22, v22, v128
    v_add_f32 v22, v22, v129
    v_add_f32 v22, v22, v130
    v_add_f32 v22, v22, v131
    v_add_f32 v22, v22, v132
    v_add_f32 v22, v22, v133
    v_add_f32 v22, v22, v134
    v_add_f32 v22, v22, v135
    v_cvt_pk_bf16_f32 v128, v128, v129
    v_cvt_pk_bf16_f32 v129, v130, v131
    v_cvt_pk_bf16_f32 v130, v132, v133
    v_cvt_pk_bf16_f32 v131, v134, v135
    s_branch L_ret0
L_slow1:
    s_waitcnt lgkmcnt(0)
    v_mfma_f32_16x16x32_bf16 v[160:163], v[80:83], v[112:115], v[160:163]
    v_mfma_f32_16x16x32_bf16 v[164:167], v[80:83], v[120:123], v[164:167]
    v_mfma_f32_16x16x32_bf16 v[168:171], v[80:83], v[128:131], v[168:171]
    v_mfma_f32_16x16x32_bf16 v[172:175], v[84:87], v[112:115], v[172:175]
    v_mfma_f32_16x16x32_bf16 v[176:179], v[84:87], v[120:123], v[176:179]
    v_mfma_f32_16x16x32_bf16 v[180:183], v[84:87], v[128:131], v[180:183]
    v_mfma_f32_16x16x32_bf16 v[184:187], v[88:91], v[112:115], v[184:187]
    v_mfma_f32_16x16x32_bf16 v[188:191], v[88:91], v[120:123], v[188:191]
    v_mfma_f32_16x16x32_bf16 v[192:195], v[88:91], v[128:131], v[192:195]
    v_mfma_f32_16x16x32_bf16 v[196:199], v[92:95], v[112:115], v[196:199]
    v_mfma_f32_16x16x32_bf16 v[200:203], v[92:95], v[120:123], v[200:203]
    v_mfma_f32_16x16x32_bf16 v[204:207], v[92:95], v[128:131], v[204:207]
    v_mfma_f32_16x16x32_bf16 v[208:211], v[96:99], v[112:115], v[208:211]
    v_mfma_f32_16x16x32_bf16 v[212:215], v[96:99], v[120:123], v[212:215]
    v_mfma_f32_16x16x32_bf16 v[216:219], v[96:99], v[128:131], v[216:219]
    v_mfma_f32_16x16x32_bf16 v[220:223], v[100:103], v[112:115], v[220:223]
    v_mfma_f32_16x16x32_bf16 v[224:227], v[100:103], v[120:123], v[224:227]
    v_mfma_f32_16x16x32_bf16 v[228:231], v[100:103], v[128:131], v[228:231]
    v_mfma_f32_16x16x32_bf16 v[232:235], v[104:107], v[112:115], v[232:235]
    v_mfma_f32_16x16x32_bf16 v[236:239], v[104:107], v[120:123], v[236:239]
    v_mfma_f32_16x16x32_bf16 v[240:243], v[104:107], v[128:131], v[240:243]
    v_mfma_f32_16x16x32_bf16 v[244:247], v[108:111], v[112:115], v[244:247]
    v_mfma_f32_16x16x32_bf16 v[248:251], v[108:111], v[120:123], v[248:251]
    v_mfma_f32_16x16x32_bf16 v[252:255], v[108:111], v[128:131], v[252:255]
    s_mov_b32 m0, s25
    s_nop 0
    buffer_load_dwordx4 v1, s[8:11], s21 offen offset:0 lds
    buffer_load_dwordx4 v2, s[8:11], s21 offen offset:1024 lds
    buffer_load_dwordx4 v3, s[8:11], s21 offen offset:2048 lds
    buffer_load_dwordx4 v4, s[8:11], s21 offen offset:3072 lds
    s_add_u32 s21, s21, 16384
    s_add_u32 s25, s25, s48
    s_cmp_eq_u32 s25, s50
    s_cselect_b32 s25, s43, s25
    ds_read_b128 v[80:83], v5 offset:16384
    ds_read_b128 v[84:87], v6 offset:16384
    ds_read_b128 v[88:91], v7 offset:16384
    ds_read_b128 v[92:95], v8 offset:16384
    ds_read_b128 v[96:99], v5 offset:20480
    ds_read_b128 v[100:103], v6 offset:20480
    ds_read_b128 v[104:107], v7 offset:20480
    ds_read_b128 v[108:111], v8 offset:20480
    s_nop 7
    v_mov_b32 v29, v23
    s_nop 1
    v_permlane32_swap_b32 v23, v29
    s_nop 1
    v_max_f32 v23, v23, v29
    v_mov_b32 v29, v23
    s_nop 1
    v_permlane16_swap_b32 v23, v29
    s_nop 1
    v_max_f32 v23, v23, v29
    v_mul_f32 v23, s20, v23
    v_max_f32 v23, v23, v17
    v_sub_f32 v29, v17, v23
    v_exp_f32 v29, v29
    v_mov_b32 v17, v23
    v_mul_f32 v20, v20, v29
    v_mul_f32 v160, v160, v29
    v_mul_f32 v161, v161, v29
    v_mul_f32 v162, v162, v29
    v_mul_f32 v163, v163, v29
    v_mul_f32 v172, v172, v29
    v_mul_f32 v173, v173, v29
    v_mul_f32 v174, v174, v29
    v_mul_f32 v175, v175, v29
    v_mul_f32 v184, v184, v29
    v_mul_f32 v185, v185, v29
    v_mul_f32 v186, v186, v29
    v_mul_f32 v187, v187, v29
    v_mul_f32 v196, v196, v29
    v_mul_f32 v197, v197, v29
    v_mul_f32 v198, v198, v29
    v_mul_f32 v199, v199, v29
    v_mul_f32 v208, v208, v29
    v_mul_f32 v209, v209, v29
    v_mul_f32 v210, v210, v29
    v_mul_f32 v211, v211, v29
    v_mul_f32 v220, v220, v29
    v_mul_f32 v221, v221, v29
    v_mul_f32 v222, v222, v29
    v_mul_f32 v223, v223, v29
    v_mul_f32 v232, v232, v29
    v_mul_f32 v233, v233, v29
    v_mul_f32 v234, v234, v29
    v_mul_f32 v235, v235, v29
    v_mul_f32 v244, v244, v29
    v_mul_f32 v245, v245, v29
    v_mul_f32 v246, v246, v29
    v_mul_f32 v247, v247, v29
    v_mov_b32 v29, v24
    s_nop 1
    v_permlane32_swap_b32 v24, v29
    s_nop 1
    v_max_f32 v24, v24, v29
    v_mov_b32 v29, v24
    s_nop 1
    v_permlane16_swap_b32 v24, v29
    s_nop 1
    v_max_f32 v24, v24, v29
    v_mul_f32 v24, s20, v24
    v_max_f32 v24, v24, v18
    v_sub_f32 v29, v18, v24
    v_exp_f32 v29, v29
    v_mov_b32 v18, v24
    v_mul_f32 v21, v21, v29
    v_mul_f32 v164, v164, v29
    v_mul_f32 v165, v165, v29
    v_mul_f32 v166, v166, v29
    v_mul_f32 v167, v167, v29
    v_mul_f32 v176, v176, v29
    v_mul_f32 v177, v177, v29
    v_mul_f32 v178, v178, v29
    v_mul_f32 v179, v179, v29
    v_mul_f32 v188, v188, v29
    v_mul_f32 v189, v189, v29
    v_mul_f32 v190, v190, v29
    v_mul_f32 v191, v191, v29
    v_mul_f32 v200, v200, v29
    v_mul_f32 v201, v201, v29
    v_mul_f32 v202, v202, v29
    v_mul_f32 v203, v203, v29
    v_mul_f32 v212, v212, v29
    v_mul_f32 v213, v213, v29
    v_mul_f32 v214, v214, v29
    v_mul_f32 v215, v215, v29
    v_mul_f32 v224, v224, v29
    v_mul_f32 v225, v225, v29
    v_mul_f32 v226, v226, v29
    v_mul_f32 v227, v227, v29
    v_mul_f32 v236, v236, v29
    v_mul_f32 v237, v237, v29
    v_mul_f32 v238, v238, v29
    v_mul_f32 v239, v239, v29
    v_mul_f32 v248, v248, v29
    v_mul_f32 v249, v249, v29
    v_mul_f32 v250, v250, v29
    v_mul_f32 v251, v251, v29
    v_mov_b32 v29, v25
    s_nop 1
    v_permlane32_swap_b32 v25, v29
    s_nop 1
    v_max_f32 v25, v25, v29
    v_mov_b32 v29, v25
    s_nop 1
    v_permlane16_swap_b32 v25, v29
    s_nop 1
    v_max_f32 v25, v25, v29
    v_mul_f32 v25, s20, v25
    v_max_f32 v25, v25, v19
    v_sub_f32 v29, v19, v25
    v_exp_f32 v29, v29
    v_mov_b32 v19, v25
    v_mul_f32 v22, v22, v29
    v_mul_f32 v168, v168, v29
    v_mul_f32 v169, v169, v29
    v_mul_f32 v170, v170, v29
    v_mul_f32 v171, v171, v29
    v_mul_f32 v180, v180, v29
    v_mul_f32 v181, v181, v29
    v_mul_f32 v182, v182, v29
    v_mul_f32 v183, v183, v29
    v_mul_f32 v192, v192, v29
    v_mul_f32 v193, v193, v29
    v_mul_f32 v194, v194, v29
    v_mul_f32 v195, v195, v29
    v_mul_f32 v204, v204, v29
    v_mul_f32 v205, v205, v29
    v_mul_f32 v206, v206, v29
    v_mul_f32 v207, v207, v29
    v_mul_f32 v216, v216, v29
    v_mul_f32 v217, v217, v29
    v_mul_f32 v218, v218, v29
    v_mul_f32 v219, v219, v29
    v_mul_f32 v228, v228, v29
    v_mul_f32 v229, v229, v29
    v_mul_f32 v230, v230, v29
    v_mul_f32 v231, v231, v29
    v_mul_f32 v240, v240, v29
    v_mul_f32 v241, v241, v29
    v_mul_f32 v242, v242, v29
    v_mul_f32 v243, v243, v29
    v_mul_f32 v252, v252, v29
    v_mul_f32 v253, v253, v29
    v_mul_f32 v254, v254, v29
    v_mul_f32 v255, v255, v29
    s_waitcnt lgkmcnt(0)
    v_mfma_f32_16x16x32_bf16 v[112:115], v[80:83], v[32:35], 0
    v_mfma_f32_16x16x32_bf16 v[120:123], v[80:83], v[48:51], 0
    v_mfma_f32_16x16x32_bf16 v[128:131], v[80:83], v[64:67], 0
    v_mfma_f32_16x16x32_bf16 v[112:115], v[84:87], v[36:39], v[112:115]
    v_mfma_f32_16x16x32_bf16 v[120:123], v[84:87], v[52:55], v[120:123]
    v_mfma_f32_16x16x32_bf16 v[128:131], v[84:87], v[68:71], v[128:131]
    v_mfma_f32_16x16x32_bf16 v[112:115], v[88:91], v[40:43], v[112:115]
    v_mfma_f32_16x16x32_bf16 v[120:123], v[88:91], v[56:59], v[120:123]
    v_mfma_f32_16x16x32_bf16 v[128:131], v[88:91], v[72:75], v[128:131]
    v_mfma_f32_16x16x32_bf16 v[112:115], v[92:95], v[44:47], v[112:115]
    v_mfma_f32_16x16x32_bf16 v[120:123], v[92:95], v[60:63], v[120:123]
    v_mfma_f32_16x16x32_bf16 v[128:131], v[92:95], v[76:79], v[128:131]
    v_mfma_f32_16x16x32_bf16 v[116:119], v[96:99], v[32:35], 0
    v_mfma_f32_16x16x32_bf16 v[124:127], v[96:99], v[48:51], 0
    v_mfma_f32_16x16x32_bf16 v[132:135], v[96:99], v[64:67], 0
    v_mfma_f32_16x16x32_bf16 v[116:119], v[100:103], v[36:39], v[116:119]
    v_mfma_f32_16x16x32_bf16 v[124:127], v[100:103], v[52:55], v[124:127]
    v_mfma_f32_16x16x32_bf16 v[132:135], v[100:103], v[68:71], v[132:135]
    v_mfma_f32_16x16x32_bf16 v[116:119], v[104:107], v[40:43], v[116:119]
    v_mfma_f32_16x16x32_bf16 v[124:127], v[104:107], v[56:59], v[124:127]
    v_mfma_f32_16x16x32_bf16 v[132:135], v[104:107], v[72:75], v[132:135]
    v_mfma_f32_16x16x32_bf16 v[116:119], v[108:111], v[44:47], v[116:119]
    v_mfma_f32_16x16x32_bf16 v[124:127], v[108:111], v[60:63], v[124:127]
    v_mfma_f32_16x16x32_bf16 v[132:135], v[108:111], v[76:79], v[132:135]
    ds_read_b64_tr_b16 v[80:81], v9 offset:16384
    ds_read_b64_tr_b16 v[82:83], v9 offset:20480
    ds_read_b64_tr_b16 v[84:85], v10 offset:16384
    ds_read_b64_tr_b16 v[86:87], v10 offset:20480
    ds_read_b64_tr_b16 v[88:89], v11 offset:16384
    ds_read_b64_tr_b16 v[90:91], v11 offset:20480
    ds_read_b64_tr_b16 v[92:93], v12 offset:16384
    ds_read_b64_tr_b16 v[94:95], v12 offset:20480
    ds_read_b64_tr_b16 v[96:97], v13 offset:16384
    ds_read_b64_tr_b16 v[98:99], v13 offset:20480
    ds_read_b64_tr_b16 v[100:101], v14 offset:16384
    ds_read_b64_tr_b16 v[102:103], v14 offset:20480
    ds_read_b64_tr_b16 v[104:105], v15 offset:16384
    ds_read_b64_tr_b16 v[106:107], v15 offset:20480
    ds_read_b64_tr_b16 v[108:109], v16 offset:16384
    ds_read_b64_tr_b16 v[110:111], v16 offset:20480
    v_fma_f32 v136, v136, s20, -v17
    v_fma_f32 v137, v137, s20, -v17
    v_fma_f32 v138, v138, s20, -v17
    v_fma_f32 v139, v139, s20, -v17
    v_fma_f32 v140, v140, s20, -v17
    v_fma_f32 v141, v141, s20, -v17
    v_fma_f32 v142, v142, s20, -v17
    v_fma_f32 v143, v143, s20, -v17
    v_exp_f32 v136, v136
    v_exp_f32 v137, v137
    v_exp_f32 v138, v138
    v_exp_f32 v139, v139
    v_exp_f32 v140, v140
    v_exp_f32 v141, v141
    v_exp_f32 v142, v142
    v_exp_f32 v143, v143
    v_add_f32 v20, v20, v136
    v_add_f32 v20, v20, v137
    v_add_f32 v20, v20, v138
    v_add_f32 v20, v20, v139
    v_add_f32 v20, v20, v140
    v_add_f32 v20, v20, v141
    v_add_f32 v20, v20, v142
    v_add_f32 v20, v20, v143
    v_cvt_pk_bf16_f32 v136, v136, v137
    v_cvt_pk_bf16_f32 v137, v138, v139
    v_cvt_pk_bf16_f32 v138, v140, v141
    v_cvt_pk_bf16_f32 v139, v142, v143
    v_fma_f32 v144, v144, s20, -v18
    v_fma_f32 v145, v145, s20, -v18
    v_fma_f32 v146, v146, s20, -v18
    v_fma_f32 v147, v147, s20, -v18
    v_fma_f32 v148, v148, s20, -v18
    v_fma_f32 v149, v149, s20, -v18
    v_fma_f32 v150, v150, s20, -v18
    v_fma_f32 v151, v151, s20, -v18
    v_exp_f32 v144, v144
    v_exp_f32 v145, v145
    v_exp_f32 v146, v146
    v_exp_f32 v147, v147
    v_exp_f32 v148, v148
    v_exp_f32 v149, v149
    v_exp_f32 v150, v150
    v_exp_f32 v151, v151
    v_add_f32 v21, v21, v144
    v_add_f32 v21, v21, v145
    v_add_f32 v21, v21, v146
    v_add_f32 v21, v21, v147
    v_add_f32 v21, v21, v148
    v_add_f32 v21, v21, v149
    v_add_f32 v21, v21, v150
    v_add_f32 v21, v21, v151
    v_cvt_pk_bf16_f32 v144, v144, v145
    v_cvt_pk_bf16_f32 v145, v146, v147
    v_cvt_pk_bf16_f32 v146, v148, v149
    v_cvt_pk_bf16_f32 v147, v150, v151
    v_fma_f32 v152, v152, s20, -v19
    v_fma_f32 v153, v153, s20, -v19
    v_fma_f32 v154, v154, s20, -v19
    v_fma_f32 v155, v155, s20, -v19
    v_fma_f32 v156, v156, s20, -v19
    v_fma_f32 v157, v157, s20, -v19
    v_fma_f32 v158, v158, s20, -v19
    v_fma_f32 v159, v159, s20, -v19
    v_exp_f32 v152, v152
    v_exp_f32 v153, v153
    v_exp_f32 v154, v154
    v_exp_f32 v155, v155
    v_exp_f32 v156, v156
    v_exp_f32 v157, v157
    v_exp_f32 v158, v158
    v_exp_f32 v159, v159
    v_add_f32 v22, v22, v152
    v_add_f32 v22, v22, v153
    v_add_f32 v22, v22, v154
    v_add_f32 v22, v22, v155
    v_add_f32 v22, v22, v156
    v_add_f32 v22, v22, v157
    v_add_f32 v22, v22, v158
    v_add_f32 v22, v22, v159
    v_cvt_pk_bf16_f32 v152, v152, v153
    v_cvt_pk_bf16_f32 v153, v154, v155
    v_cvt_pk_bf16_f32 v154, v156, v157
    v_cvt_pk_bf16_f32 v155, v158, v159
    s_branch L_ret1
L_slow2:
    s_waitcnt lgkmcnt(0)
    v_mfma_f32_16x16x32_bf16 v[160:163], v[80:83], v[136:139], v[160:163]
    v_mfma_f32_16x16x32_bf16 v[164:167], v[80:83], v[144:147], v[164:167]
    v_mfma_f32_16x16x32_bf16 v[168:171], v[80:83], v[152:155], v[168:171]
    v_mfma_f32_16x16x32_bf16 v[172:175], v[84:87], v[136:139], v[172:175]
    v_mfma_f32_16x16x32_bf16 v[176:179], v[84:87], v[144:147], v[176:179]
    v_mfma_f32_16x16x32_bf16 v[180:183], v[84:87], v[152:155], v[180:183]
    v_mfma_f32_16x16x32_bf16 v[184:187], v[88:91], v[136:139], v[184:187]
    v_mfma_f32_16x16x32_bf16 v[188:191], v[88:91], v[144:147], v[188:191]
    v_mfma_f32_16x16x32_bf16 v[192:195], v[88:91], v[152:155], v[192:195]
    v_mfma_f32_16x16x32_bf16 v[196:199], v[92:95], v[136:139], v[196:199]
    v_mfma_f32_16x16x32_bf16 v[200:203], v[92:95], v[144:147], v[200:203]
    v_mfma_f32_16x16x32_bf16 v[204:207], v[92:95], v[152:155], v[204:207]
    v_mfma_f32_16x16x32_bf16 v[208:211], v[96:99], v[136:139], v[208:211]
    v_mfma_f32_16x16x32_bf16 v[212:215], v[96:99], v[144:147], v[212:215]
    v_mfma_f32_16x16x32_bf16 v[216:219], v[96:99], v[152:155], v[216:219]
    v_mfma_f32_16x16x32_bf16 v[220:223], v[100:103], v[136:139], v[220:223]
    v_mfma_f32_16x16x32_bf16 v[224:227], v[100:103], v[144:147], v[224:227]
    v_mfma_f32_16x16x32_bf16 v[228:231], v[100:103], v[152:155], v[228:231]
    v_mfma_f32_16x16x32_bf16 v[232:235], v[104:107], v[136:139], v[232:235]
    v_mfma_f32_16x16x32_bf16 v[236:239], v[104:107], v[144:147], v[236:239]
    v_mfma_f32_16x16x32_bf16 v[240:243], v[104:107], v[152:155], v[240:243]
    v_mfma_f32_16x16x32_bf16 v[244:247], v[108:111], v[136:139], v[244:247]
    v_mfma_f32_16x16x32_bf16 v[248:251], v[108:111], v[144:147], v[248:251]
    v_mfma_f32_16x16x32_bf16 v[252:255], v[108:111], v[152:155], v[252:255]
    s_mov_b32 m0, s25
    s_nop 0
    buffer_load_dwordx4 v1, s[8:11], s21 offen offset:0 lds
    buffer_load_dwordx4 v2, s[8:11], s21 offen offset:1024 lds
    buffer_load_dwordx4 v3, s[8:11], s21 offen offset:2048 lds
    buffer_load_dwordx4 v4, s[8:11], s21 offen offset:3072 lds
    s_add_u32 s21, s21, 16384
    s_add_u32 s25, s25, s48
    s_cmp_eq_u32 s25, s50
    s_cselect_b32 s25, s43, s25
    ds_read_b128 v[80:83], v5 offset:24576
    ds_read_b128 v[84:87], v6 offset:24576
    ds_read_b128 v[88:91], v7 offset:24576
    ds_read_b128 v[92:95], v8 offset:24576
    ds_read_b128 v[96:99], v5 offset:28672
    ds_read_b128 v[100:103], v6 offset:28672
    ds_read_b128 v[104:107], v7 offset:28672
    ds_read_b128 v[108:111], v8 offset:28672
    s_nop 7
    v_mov_b32 v29, v23
    s_nop 1
    v_permlane32_swap_b32 v23, v29
    s_nop 1
    v_max_f32 v23, v23, v29
    v_mov_b32 v29, v23
    s_nop 1
    v_permlane16_swap_b32 v23, v29
    s_nop 1
    v_max_f32 v23, v23, v29
    v_mul_f32 v23, s20, v23
    v_max_f32 v23, v23, v17
    v_sub_f32 v29, v17, v23
    v_exp_f32 v29, v29
    v_mov_b32 v17, v23
    v_mul_f32 v20, v20, v29
    v_mul_f32 v160, v160, v29
    v_mul_f32 v161, v161, v29
    v_mul_f32 v162, v162, v29
    v_mul_f32 v163, v163, v29
    v_mul_f32 v172, v172, v29
    v_mul_f32 v173, v173, v29
    v_mul_f32 v174, v174, v29
    v_mul_f32 v175, v175, v29
    v_mul_f32 v184, v184, v29
    v_mul_f32 v185, v185, v29
    v_mul_f32 v186, v186, v29
    v_mul_f32 v187, v187, v29
    v_mul_f32 v196, v196, v29
    v_mul_f32 v197, v197, v29
    v_mul_f32 v198, v198, v29
    v_mul_f32 v199, v199, v29
    v_mul_f32 v208, v208, v29
    v_mul_f32 v209, v209, v29
    v_mul_f32 v210, v210, v29
    v_mul_f32 v211, v211, v29
    v_mul_f32 v220, v220, v29
    v_mul_f32 v221, v221, v29
    v_mul_f32 v222, v222, v29
    v_mul_f32 v223, v223, v29
    v_mul_f32 v232, v232, v29
    v_mul_f32 v233, v233, v29
    v_mul_f32 v234, v234, v29
    v_mul_f32 v235, v235, v29
    v_mul_f32 v244, v244, v29
    v_mul_f32 v245, v245, v29
    v_mul_f32 v246, v246, v29
    v_mul_f32 v247, v247, v29
    v_mov_b32 v29, v24
    s_nop 1
    v_permlane32_swap_b32 v24, v29
    s_nop 1
    v_max_f32 v24, v24, v29
    v_mov_b32 v29, v24
    s_nop 1
    v_permlane16_swap_b32 v24, v29
    s_nop 1
    v_max_f32 v24, v24, v29
    v_mul_f32 v24, s20, v24
    v_max_f32 v24, v24, v18
    v_sub_f32 v29, v18, v24
    v_exp_f32 v29, v29
    v_mov_b32 v18, v24
    v_mul_f32 v21, v21, v29
    v_mul_f32 v164, v164, v29
    v_mul_f32 v165, v165, v29
    v_mul_f32 v166, v166, v29
    v_mul_f32 v167, v167, v29
    v_mul_f32 v176, v176, v29
    v_mul_f32 v177, v177, v29
    v_mul_f32 v178, v178, v29
    v_mul_f32 v179, v179, v29
    v_mul_f32 v188, v188, v29
    v_mul_f32 v189, v189, v29
    v_mul_f32 v190, v190, v29
    v_mul_f32 v191, v191, v29
    v_mul_f32 v200, v200, v29
    v_mul_f32 v201, v201, v29
    v_mul_f32 v202, v202, v29
    v_mul_f32 v203, v203, v29
    v_mul_f32 v212, v212, v29
    v_mul_f32 v213, v213, v29
    v_mul_f32 v214, v214, v29
    v_mul_f32 v215, v215, v29
    v_mul_f32 v224, v224, v29
    v_mul_f32 v225, v225, v29
    v_mul_f32 v226, v226, v29
    v_mul_f32 v227, v227, v29
    v_mul_f32 v236, v236, v29
    v_mul_f32 v237, v237, v29
    v_mul_f32 v238, v238, v29
    v_mul_f32 v239, v239, v29
    v_mul_f32 v248, v248, v29
    v_mul_f32 v249, v249, v29
    v_mul_f32 v250, v250, v29
    v_mul_f32 v251, v251, v29
    v_mov_b32 v29, v25
    s_nop 1
    v_permlane32_swap_b32 v25, v29
    s_nop 1
    v_max_f32 v25, v25, v29
    v_mov_b32 v29, v25
    s_nop 1
    v_permlane16_swap_b32 v25, v29
    s_nop 1
    v_max_f32 v25, v25, v29
    v_mul_f32 v25, s20, v25
    v_max_f32 v25, v25, v19
    v_sub_f32 v29, v19, v25
    v_exp_f32 v29, v29
    v_mov_b32 v19, v25
    v_mul_f32 v22, v22, v29
    v_mul_f32 v168, v168, v29
    v_mul_f32 v169, v169, v29
    v_mul_f32 v170, v170, v29
    v_mul_f32 v171, v171, v29
    v_mul_f32 v180, v180, v29
    v_mul_f32 v181, v181, v29
    v_mul_f32 v182, v182, v29
    v_mul_f32 v183, v183, v29
    v_mul_f32 v192, v192, v29
    v_mul_f32 v193, v193, v29
    v_mul_f32 v194, v194, v29
    v_mul_f32 v195, v195, v29
    v_mul_f32 v204, v204, v29
    v_mul_f32 v205, v205, v29
    v_mul_f32 v206, v206, v29
    v_mul_f32 v207, v207, v29
    v_mul_f32 v216, v216, v29
    v_mul_f32 v217, v217, v29
    v_mul_f32 v218, v218, v29
    v_mul_f32 v219, v219, v29
    v_mul_f32 v228, v228, v29
    v_mul_f32 v229, v229, v29
    v_mul_f32 v230, v230, v29
    v_mul_f32 v231, v231, v29
    v_mul_f32 v240, v240, v29
    v_mul_f32 v241, v241, v29
    v_mul_f32 v242, v242, v29
    v_mul_f32 v243, v243, v29
    v_mul_f32 v252, v252, v29
    v_mul_f32 v253, v253, v29
    v_mul_f32 v254, v254, v29
    v_mul_f32 v255, v255, v29
    s_waitcnt lgkmcnt(0)
    v_mfma_f32_16x16x32_bf16 v[136:139], v[80:83], v[32:35], 0
    v_mfma_f32_16x16x32_bf16 v[144:147], v[80:83], v[48:51], 0
    v_mfma_f32_16x16x32_bf16 v[152:155], v[80:83], v[64:67], 0
    v_mfma_f32_16x16x32_bf16 v[136:139], v[84:87], v[36:39], v[136:139]
    v_mfma_f32_16x16x32_bf16 v[144:147], v[84:87], v[52:55], v[144:147]
    v_mfma_f32_16x16x32_bf16 v[152:155], v[84:87], v[68:71], v[152:155]
    v_mfma_f32_16x16x32_bf16 v[136:139], v[88:91], v[40:43], v[136:139]
    v_mfma_f32_16x16x32_bf16 v[144:147], v[88:91], v[56:59], v[144:147]
    v_mfma_f32_16x16x32_bf16 v[152:155], v[88:91], v[72:75], v[152:155]
    v_mfma_f32_16x16x32_bf16 v[136:139], v[92:95], v[44:47], v[136:139]
    v_mfma_f32_16x16x32_bf16 v[144:147], v[92:95], v[60:63], v[144:147]
    v_mfma_f32_16x16x32_bf16 v[152:155], v[92:95], v[76:79], v[152:155]
    v_mfma_f32_16x16x32_bf16 v[140:143], v[96:99], v[32:35], 0
    v_mfma_f32_16x16x32_bf16 v[148:151], v[96:99], v[48:51], 0
    v_mfma_f32_16x16x32_bf16 v[156:159], v[96:99], v[64:67], 0
    v_mfma_f32_16x16x32_bf16 v[140:143], v[100:103], v[36:39], v[140:143]
    v_mfma_f32_16x16x32_bf16 v[148:151], v[100:103], v[52:55], v[148:151]
    v_mfma_f32_16x16x32_bf16 v[156:159], v[100:103], v[68:71], v[156:159]
    v_mfma_f32_16x16x32_bf16 v[140:143], v[104:107], v[40:43], v[140:143]
    v_mfma_f32_16x16x32_bf16 v[148:151], v[104:107], v[56:59], v[148:151]
    v_mfma_f32_16x16x32_bf16 v[156:159], v[104:107], v[72:75], v[156:159]
    v_mfma_f32_16x16x32_bf16 v[140:143], v[108:111], v[44:47], v[140:143]
    v_mfma_f32_16x16x32_bf16 v[148:151], v[108:111], v[60:63], v[148:151]
    v_mfma_f32_16x16x32_bf16 v[156:159], v[108:111], v[76:79], v[156:159]
    ds_read_b64_tr_b16 v[80:81], v9 offset:32768
    ds_read_b64_tr_b16 v[82:83], v9 offset:36864
    ds_read_b64_tr_b16 v[84:85], v10 offset:32768
    ds_read_b64_tr_b16 v[86:87], v10 offset:36864
    ds_read_b64_tr_b16 v[88:89], v11 offset:32768
    ds_read_b64_tr_b16 v[90:91], v11 offset:36864
    ds_read_b64_tr_b16 v[92:93], v12 offset:32768
    ds_read_b64_tr_b16 v[94:95], v12 offset:36864
    ds_read_b64_tr_b16 v[96:97], v13 offset:32768
    ds_read_b64_tr_b16 v[98:99], v13 offset:36864
    ds_read_b64_tr_b16 v[100:101], v14 offset:32768
    ds_read_b64_tr_b16 v[102:103], v14 offset:36864
    ds_read_b64_tr_b16 v[104:105], v15 offset:32768
    ds_read_b64_tr_b16 v[106:107], v15 offset:36864
    ds_read_b64_tr_b16 v[108:109], v16 offset:32768
    ds_read_b64_tr_b16 v[110:111], v16 offset:36864
    v_fma_f32 v112, v112, s20, -v17
    v_fma_f32 v113, v113, s20, -v17
    v_fma_f32 v114, v114, s20, -v17
    v_fma_f32 v115, v115, s20, -v17
    v_fma_f32 v116, v116, s20, -v17
    v_fma_f32 v117, v117, s20, -v17
    v_fma_f32 v118, v118, s20, -v17
    v_fma_f32 v119, v119, s20, -v17
    v_exp_f32 v112, v112
    v_exp_f32 v113, v113
    v_exp_f32 v114, v114
    v_exp_f32 v115, v115
    v_exp_f32 v116, v116
    v_exp_f32 v117, v117
    v_exp_f32 v118, v118
    v_exp_f32 v119, v119
    v_add_f32 v20, v20, v112
    v_add_f32 v20, v20, v113
    v_add_f32 v20, v20, v114
    v_add_f32 v20, v20, v115
    v_add_f32 v20, v20, v116
    v_add_f32 v20, v20, v117
    v_add_f32 v20, v20, v118
    v_add_f32 v20, v20, v119
    v_cvt_pk_bf16_f32 v112, v112, v113
    v_cvt_pk_bf16_f32 v113, v114, v115
    v_cvt_pk_bf16_f32 v114, v116, v117
    v_cvt_pk_bf16_f32 v115, v118, v119
    v_fma_f32 v120, v120, s20, -v18
    v_fma_f32 v121, v121, s20, -v18
    v_fma_f32 v122, v122, s20, -v18
    v_fma_f32 v123, v123, s20, -v18
    v_fma_f32 v124, v124, s20, -v18
    v_fma_f32 v125, v125, s20, -v18
    v_fma_f32 v126, v126, s20, -v18
    v_fma_f32 v127, v127, s20, -v18
    v_exp_f32 v120, v120
    v_exp_f32 v121, v121
    v_exp_f32 v122, v122
    v_exp_f32 v123, v123
    v_exp_f32 v124, v124
    v_exp_f32 v125, v125
    v_exp_f32 v126, v126
    v_exp_f32 v127, v127
    v_add_f32 v21, v21, v120
    v_add_f32 v21, v21, v121
    v_add_f32 v21, v21, v122
    v_add_f32 v21, v21, v123
    v_add_f32 v21, v21, v124
    v_add_f32 v21, v21, v125
    v_add_f32 v21, v21, v126
    v_add_f32 v21, v21, v127
    v_cvt_pk_bf16_f32 v120, v120, v121
    v_cvt_pk_bf16_f32 v121, v122, v123
    v_cvt_pk_bf16_f32 v122, v124, v125
    v_cvt_pk_bf16_f32 v123, v126, v127
    v_fma_f32 v128, v128, s20, -v19
    v_fma_f32 v129, v129, s20, -v19
    v_fma_f32 v130, v130, s20, -v19
    v_fma_f32 v131, v131, s20, -v19
    v_fma_f32 v132, v132, s20, -v19
    v_fma_f32 v133, v133, s20, -v19
    v_fma_f32 v134, v134, s20, -v19
    v_fma_f32 v135, v135, s20, -v19
    v_exp_f32 v128, v128
    v_exp_f32 v129, v129
    v_exp_f32 v130, v130
    v_exp_f32 v131, v131
    v_exp_f32 v132, v132
    v_exp_f32 v133, v133
    v_exp_f32 v134, v134
    v_exp_f32 v135, v135
    v_add_f32 v22, v22, v128
    v_add_f32 v22, v22, v129
    v_add_f32 v22, v22, v130
    v_add_f32 v22, v22, v131
    v_add_f32 v22, v22, v132
    v_add_f32 v22, v22, v133
    v_add_f32 v22, v22, v134
    v_add_f32 v22, v22, v135
    v_cvt_pk_bf16_f32 v128, v128, v129
    v_cvt_pk_bf16_f32 v129, v130, v131
    v_cvt_pk_bf16_f32 v130, v132, v133
    v_cvt_pk_bf16_f32 v131, v134, v135
    s_branch L_ret2
L_slow3:
    s_waitcnt lgkmcnt(0)
    v_mfma_f32_16x16x32_bf16 v[160:163], v[80:83], v[112:115], v[160:163]
    v_mfma_f32_16x16x32_bf16 v[164:167], v[80:83], v[120:123], v[164:167]
    v_mfma_f32_16x16x32_bf16 v[168:171], v[80:83], v[128:131], v[168:171]
    v_mfma_f32_16x16x32_bf16 v[172:175], v[84:87], v[112:115], v[172:175]
    v_mfma_f32_16x16x32_bf16 v[176:179], v[84:87], v[120:123], v[176:179]
    v_mfma_f32_16x16x32_bf16 v[180:183], v[84:87], v[128:131], v[180:183]
    v_mfma_f32_16x16x32_bf16 v[184:187], v[88:91], v[112:115], v[184:187]
    v_mfma_f32_16x16x32_bf16 v[188:191], v[88:91], v[120:123], v[188:191]
    v_mfma_f32_16x16x32_bf16 v[192:195], v[88:91], v[128:131], v[192:195]
    v_mfma_f32_16x16x32_bf16 v[196:199], v[92:95], v[112:115], v[196:199]
    v_mfma_f32_16x16x32_bf16 v[200:203], v[92:95], v[120:123], v[200:203]
    v_mfma_f32_16x16x32_bf16 v[204:207], v[92:95], v[128:131], v[204:207]
    v_mfma_f32_16x16x32_bf16 v[208:211], v[96:99], v[112:115], v[208:211]
    v_mfma_f32_16x16x32_bf16 v[212:215], v[96:99], v[120:123], v[212:215]
    v_mfma_f32_16x16x32_bf16 v[216:219], v[96:99], v[128:131], v[216:219]
    v_mfma_f32_16x16x32_bf16 v[220:223], v[100:103], v[112:115], v[220:223]
    v_mfma_f32_16x16x32_bf16 v[224:227], v[100:103], v[120:123], v[224:227]
    v_mfma_f32_16x16x32_bf16 v[228:231], v[100:103], v[128:131], v[228:231]
    v_mfma_f32_16x16x32_bf16 v[232:235], v[104:107], v[112:115], v[232:235]
    v_mfma_f32_16x16x32_bf16 v[236:239], v[104:107], v[120:123], v[236:239]
    v_mfma_f32_16x16x32_bf16 v[240:243], v[104:107], v[128:131], v[240:243]
    v_mfma_f32_16x16x32_bf16 v[244:247], v[108:111], v[112:115], v[244:247]
    v_mfma_f32_16x16x32_bf16 v[248:251], v[108:111], v[120:123], v[248:251]
    v_mfma_f32_16x16x32_bf16 v[252:255], v[108:111], v[128:131], v[252:255]
    s_mov_b32 m0, s25
    s_nop 0
    buffer_load_dwordx4 v1, s[8:11], s21 offen offset:0 lds
    buffer_load_dwordx4 v2, s[8:11], s21 offen offset:1024 lds
    buffer_load_dwordx4 v3, s[8:11], s21 offen offset:2048 lds
    buffer_load_dwordx4 v4, s[8:11], s21 offen offset:3072 lds
    s_add_u32 s21, s21, 16384
    s_add_u32 s25, s25, s48
    s_cmp_eq_u32 s25, s50
    s_cselect_b32 s25, s43, s25
    ds_read_b128 v[80:83], v5 offset:0
    ds_read_b128 v[84:87], v6 offset:0
    ds_read_b128 v[88:91], v7 offset:0
    ds_read_b128 v[92:95], v8 offset:0
    ds_read_b128 v[96:99], v5 offset:4096
    ds_read_b128 v[100:103], v6 offset:4096
    ds_read_b128 v[104:107], v7 offset:4096
    ds_read_b128 v[108:111], v8 offset:4096
    s_nop 7
    v_mov_b32 v29, v23
    s_nop 1
    v_permlane32_swap_b32 v23, v29
    s_nop 1
    v_max_f32 v23, v23, v29
    v_mov_b32 v29, v23
    s_nop 1
    v_permlane16_swap_b32 v23, v29
    s_nop 1
    v_max_f32 v23, v23, v29
    v_mul_f32 v23, s20, v23
    v_max_f32 v23, v23, v17
    v_sub_f32 v29, v17, v23
    v_exp_f32 v29, v29
    v_mov_b32 v17, v23
    v_mul_f32 v20, v20, v29
    v_mul_f32 v160, v160, v29
    v_mul_f32 v161, v161, v29
    v_mul_f32 v162, v162, v29
    v_mul_f32 v163, v163, v29
    v_mul_f32 v172, v172, v29
    v_mul_f32 v173, v173, v29
    v_mul_f32 v174, v174, v29
    v_mul_f32 v175, v175, v29
    v_mul_f32 v184, v184, v29
    v_mul_f32 v185, v185, v29
    v_mul_f32 v186, v186, v29
    v_mul_f32 v187, v187, v29
    v_mul_f32 v196, v196, v29
    v_mul_f32 v197, v197, v29
    v_mul_f32 v198, v198, v29
    v_mul_f32 v199, v199, v29
    v_mul_f32 v208, v208, v29
    v_mul_f32 v209, v209, v29
    v_mul_f32 v210, v210, v29
    v_mul_f32 v211, v211, v29
    v_mul_f32 v220, v220, v29
    v_mul_f32 v221, v221, v29
    v_mul_f32 v222, v222, v29
    v_mul_f32 v223, v223, v29
    v_mul_f32 v232, v232, v29
    v_mul_f32 v233, v233, v29
    v_mul_f32 v234, v234, v29
    v_mul_f32 v235, v235, v29
    v_mul_f32 v244, v244, v29
    v_mul_f32 v245, v245, v29
    v_mul_f32 v246, v246, v29
    v_mul_f32 v247, v247, v29
    v_mov_b32 v29, v24
    s_nop 1
    v_permlane32_swap_b32 v24, v29
    s_nop 1
    v_max_f32 v24, v24, v29
    v_mov_b32 v29, v24
    s_nop 1
    v_permlane16_swap_b32 v24, v29
    s_nop 1
    v_max_f32 v24, v24, v29
    v_mul_f32 v24, s20, v24
    v_max_f32 v24, v24, v18
    v_sub_f32 v29, v18, v24
    v_exp_f32 v29, v29
    v_mov_b32 v18, v24
    v_mul_f32 v21, v21, v29
    v_mul_f32 v164, v164, v29
    v_mul_f32 v165, v165, v29
    v_mul_f32 v166, v166, v29
    v_mul_f32 v167, v167, v29
    v_mul_f32 v176, v176, v29
    v_mul_f32 v177, v177, v29
    v_mul_f32 v178, v178, v29
    v_mul_f32 v179, v179, v29
    v_mul_f32 v188, v188, v29
    v_mul_f32 v189, v189, v29
    v_mul_f32 v190, v190, v29
    v_mul_f32 v191, v191, v29
    v_mul_f32 v200, v200, v29
    v_mul_f32 v201, v201, v29
    v_mul_f32 v202, v202, v29
    v_mul_f32 v203, v203, v29
    v_mul_f32 v212, v212, v29
    v_mul_f32 v213, v213, v29
    v_mul_f32 v214, v214, v29
    v_mul_f32 v215, v215, v29
    v_mul_f32 v224, v224, v29
    v_mul_f32 v225, v225, v29
    v_mul_f32 v226, v226, v29
    v_mul_f32 v227, v227, v29
    v_mul_f32 v236, v236, v29
    v_mul_f32 v237, v237, v29
    v_mul_f32 v238, v238, v29
    v_mul_f32 v239, v239, v29
    v_mul_f32 v248, v248, v29
    v_mul_f32 v249, v249, v29
    v_mul_f32 v250, v250, v29
    v_mul_f32 v251, v251, v29
    v_mov_b32 v29, v25
    s_nop 1
    v_permlane32_swap_b32 v25, v29
    s_nop 1
    v_max_f32 v25, v25, v29
    v_mov_b32 v29, v25
    s_nop 1
    v_permlane16_swap_b32 v25, v29
    s_nop 1
    v_max_f32 v25, v25, v29
    v_mul_f32 v25, s20, v25
    v_max_f32 v25, v25, v19
    v_sub_f32 v29, v19, v25
    v_exp_f32 v29, v29
    v_mov_b32 v19, v25
    v_mul_f32 v22, v22, v29
    v_mul_f32 v168, v168, v29
    v_mul_f32 v169, v169, v29
    v_mul_f32 v170, v170, v29
    v_mul_f32 v171, v171, v29
    v_mul_f32 v180, v180, v29
    v_mul_f32 v181, v181, v29
    v_mul_f32 v182, v182, v29
    v_mul_f32 v183, v183, v29
    v_mul_f32 v192, v192, v29
    v_mul_f32 v193, v193, v29
    v_mul_f32 v194, v194, v29
    v_mul_f32 v195, v195, v29
    v_mul_f32 v204, v204, v29
    v_mul_f32 v205, v205, v29
    v_mul_f32 v206, v206, v29
    v_mul_f32 v207, v207, v29
    v_mul_f32 v216, v216, v29
    v_mul_f32 v217, v217, v29
    v_mul_f32 v218, v218, v29
    v_mul_f32 v219, v219, v29
    v_mul_f32 v228, v228, v29
    v_mul_f32 v229, v229, v29
    v_mul_f32 v230, v230, v29
    v_mul_f32 v231, v231, v29
    v_mul_f32 v240, v240, v29
    v_mul_f32 v241, v241, v29
    v_mul_f32 v242, v242, v29
    v_mul_f32 v243, v243, v29
    v_mul_f32 v252, v252, v29
    v_mul_f32 v253, v253, v29
    v_mul_f32 v254, v254, v29
    v_mul_f32 v255, v255, v29
    s_waitcnt lgkmcnt(0)
    v_mfma_f32_16x16x32_bf16 v[112:115], v[80:83], v[32:35], 0
    v_mfma_f32_16x16x32_bf16 v[120:123], v[80:83], v[48:51], 0
    v_mfma_f32_16x16x32_bf16 v[128:131], v[80:83], v[64:67], 0
    v_mfma_f32_16x16x32_bf16 v[112:115], v[84:87], v[36:39], v[112:115]
    v_mfma_f32_16x16x32_bf16 v[120:123], v[84:87], v[52:55], v[120:123]
    v_mfma_f32_16x16x32_bf16 v[128:131], v[84:87], v[68:71], v[128:131]
    v_mfma_f32_16x16x32_bf16 v[112:115], v[88:91], v[40:43], v[112:115]
    v_mfma_f32_16x16x32_bf16 v[120:123], v[88:91], v[56:59], v[120:123]
    v_mfma_f32_16x16x32_bf16 v[128:131], v[88:91], v[72:75], v[128:131]
    v_mfma_f32_16x16x32_bf16 v[112:115], v[92:95], v[44:47], v[112:115]
    v_mfma_f32_16x16x32_bf16 v[120:123], v[92:95], v[60:63], v[120:123]
    v_mfma_f32_16x16x32_bf16 v[128:131], v[92:95], v[76:79], v[128:131]
    v_mfma_f32_16x16x32_bf16 v[116:119], v[96:99], v[32:35], 0
    v_mfma_f32_16x16x32_bf16 v[124:127], v[96:99], v[48:51], 0
    v_mfma_f32_16x16x32_bf16 v[132:135], v[96:99], v[64:67], 0
    v_mfma_f32_16x16x32_bf16 v[116:119], v[100:103], v[36:39], v[116:119]
    v_mfma_f32_16x16x32_bf16 v[124:127], v[100:103], v[52:55], v[124:127]
    v_mfma_f32_16x16x32_bf16 v[132:135], v[100:103], v[68:71], v[132:135]
    v_mfma_f32_16x16x32_bf16 v[116:119], v[104:107], v[40:43], v[116:119]
    v_mfma_f32_16x16x32_bf16 v[124:127], v[104:107], v[56:59], v[124:127]
    v_mfma_f32_16x16x32_bf16 v[132:135], v[104:107], v[72:75], v[132:135]
    v_mfma_f32_16x16x32_bf16 v[116:119], v[108:111], v[44:47], v[116:119]
    v_mfma_f32_16x16x32_bf16 v[124:127], v[108:111], v[60:63], v[124:127]
    v_mfma_f32_16x16x32_bf16 v[132:135], v[108:111], v[76:79], v[132:135]
    ds_read_b64_tr_b16 v[80:81], v9 offset:49152
    ds_read_b64_tr_b16 v[82:83], v9 offset:53248
    ds_read_b64_tr_b16 v[84:85], v10 offset:49152
    ds_read_b64_tr_b16 v[86:87], v10 offset:53248
    ds_read_b64_tr_b16 v[88:89], v11 offset:49152
    ds_read_b64_tr_b16 v[90:91], v11 offset:53248
    ds_read_b64_tr_b16 v[92:93], v12 offset:49152
    ds_read_b64_tr_b16 v[94:95], v12 offset:53248
    ds_read_b64_tr_b16 v[96:97], v13 offset:49152
    ds_read_b64_tr_b16 v[98:99], v13 offset:53248
    ds_read_b64_tr_b16 v[100:101], v14 offset:49152
    ds_read_b64_tr_b16 v[102:103], v14 offset:53248
    ds_read_b64_tr_b16 v[104:105], v15 offset:49152
    ds_read_b64_tr_b16 v[106:107], v15 offset:53248
    ds_read_b64_tr_b16 v[108:109], v16 offset:49152
    ds_read_b64_tr_b16 v[110:111], v16 offset:53248
    v_fma_f32 v136, v136, s20, -v17
    v_fma_f32 v137, v137, s20, -v17
    v_fma_f32 v138, v138, s20, -v17
    v_fma_f32 v139, v139, s20, -v17
    v_fma_f32 v140, v140, s20, -v17
    v_fma_f32 v141, v141, s20, -v17
    v_fma_f32 v142, v142, s20, -v17
    v_fma_f32 v143, v143, s20, -v17
    v_exp_f32 v136, v136
    v_exp_f32 v137, v137
    v_exp_f32 v138, v138
    v_exp_f32 v139, v139
    v_exp_f32 v140, v140
    v_exp_f32 v141, v141
    v_exp_f32 v142, v142
    v_exp_f32 v143, v143
    v_add_f32 v20, v20, v136
    v_add_f32 v20, v20, v137
    v_add_f32 v20, v20, v138
    v_add_f32 v20, v20, v139
    v_add_f32 v20, v20, v140
    v_add_f32 v20, v20, v141
    v_add_f32 v20, v20, v142
    v_add_f32 v20, v20, v143
    v_cvt_pk_bf16_f32 v136, v136, v137
    v_cvt_pk_bf16_f32 v137, v138, v139
    v_cvt_pk_bf16_f32 v138, v140, v141
    v_cvt_pk_bf16_f32 v139, v142, v143
    v_fma_f32 v144, v144, s20, -v18
    v_fma_f32 v145, v145, s20, -v18
    v_fma_f32 v146, v146, s20, -v18
    v_fma_f32 v147, v147, s20, -v18
    v_fma_f32 v148, v148, s20, -v18
    v_fma_f32 v149, v149, s20, -v18
    v_fma_f32 v150, v150, s20, -v18
    v_fma_f32 v151, v151, s20, -v18
    v_exp_f32 v144, v144
    v_exp_f32 v145, v145
    v_exp_f32 v146, v146
    v_exp_f32 v147, v147
    v_exp_f32 v148, v148
    v_exp_f32 v149, v149
    v_exp_f32 v150, v150
    v_exp_f32 v151, v151
    v_add_f32 v21, v21, v144
    v_add_f32 v21, v21, v145
    v_add_f32 v21, v21, v146
    v_add_f32 v21, v21, v147
    v_add_f32 v21, v21, v148
    v_add_f32 v21, v21, v149
    v_add_f32 v21, v21, v150
    v_add_f32 v21, v21, v151
    v_cvt_pk_bf16_f32 v144, v144, v145
    v_cvt_pk_bf16_f32 v145, v146, v147
    v_cvt_pk_bf16_f32 v146, v148, v149
    v_cvt_pk_bf16_f32 v147, v150, v151
    v_fma_f32 v152, v152, s20, -v19
    v_fma_f32 v153, v153, s20, -v19
    v_fma_f32 v154, v154, s20, -v19
    v_fma_f32 v155, v155, s20, -v19
    v_fma_f32 v156, v156, s20, -v19
    v_fma_f32 v157, v157, s20, -v19
    v_fma_f32 v158, v158, s20, -v19
    v_fma_f32 v159, v159, s20, -v19
    v_exp_f32 v152, v152
    v_exp_f32 v153, v153
    v_exp_f32 v154, v154
    v_exp_f32 v155, v155
    v_exp_f32 v156, v156
    v_exp_f32 v157, v157
    v_exp_f32 v158, v158
    v_exp_f32 v159, v159
    v_add_f32 v22, v22, v152
    v_add_f32 v22, v22, v153
    v_add_f32 v22, v22, v154
    v_add_f32 v22, v22, v155
    v_add_f32 v22, v22, v156
    v_add_f32 v22, v22, v157
    v_add_f32 v22, v22, v158
    v_add_f32 v22, v22, v159
    v_cvt_pk_bf16_f32 v152, v152, v153
    v_cvt_pk_bf16_f32 v153, v154, v155
    v_cvt_pk_bf16_f32 v154, v156, v157
    v_cvt_pk_bf16_f32 v155, v158, v159
    s_branch L_ret3
L_slow3l:
    s_waitcnt lgkmcnt(0)
    v_mfma_f32_16x16x32_bf16 v[160:163], v[80:83], v[112:115], v[160:163]
    v_mfma_f32_16x16x32_bf16 v[164:167], v[80:83], v[120:123], v[164:167]
    v_mfma_f32_16x16x32_bf16 v[168:171], v[80:83], v[128:131], v[168:171]
    v_mfma_f32_16x16x32_bf16 v[172:175], v[84:87], v[112:115], v[172:175]
    v_mfma_f32_16x16x32_bf16 v[176:179], v[84:87], v[120:123], v[176:179]
    v_mfma_f32_16x16x32_bf16 v[180:183], v[84:87], v[128:131], v[180:183]
    v_mfma_f32_16x16x32_bf16 v[184:187], v[88:91], v[112:115], v[184:187]
    v_mfma_f32_16x16x32_bf16 v[188:191], v[88:91], v[120:123], v[188:191]
    v_mfma_f32_16x16x32_bf16 v[192:195], v[88:91], v[128:131], v[192:195]
    v_mfma_f32_16x16x32_bf16 v[196:199], v[92:95], v[112:115], v[196:199]
    v_mfma_f32_16x16x32_bf16 v[200:203], v[92:95], v[120:123], v[200:203]
    v_mfma_f32_16x16x32_bf16 v[204:207], v[92:95], v[128:131], v[204:207]
    v_mfma_f32_16x16x32_bf16 v[208:211], v[96:99], v[112:115], v[208:211]
    v_mfma_f32_16x16x32_bf16 v[212:215], v[96:99], v[120:123], v[212:215]
    v_mfma_f32_16x16x32_bf16 v[216:219], v[96:99], v[128:131], v[216:219]
    v_mfma_f32_16x16x32_bf16 v[220:223], v[100:103], v[112:115], v[220:223]
    v_mfma_f32_16x16x32_bf16 v[224:227], v[100:103], v[120:123], v[224:227]
    v_mfma_f32_16x16x32_bf16 v[228:231], v[100:103], v[128:131], v[228:231]
    v_mfma_f32_16x16x32_bf16 v[232:235], v[104:107], v[112:115], v[232:235]
    v_mfma_f32_16x16x32_bf16 v[236:239], v[104:107], v[120:123], v[236:239]
    v_mfma_f32_16x16x32_bf16 v[240:243], v[104:107], v[128:131], v[240:243]
    v_mfma_f32_16x16x32_bf16 v[244:247], v[108:111], v[112:115], v[244:247]
    v_mfma_f32_16x16x32_bf16 v[248:251], v[108:111], v[120:123], v[248:251]
    v_mfma_f32_16x16x32_bf16 v[252:255], v[108:111], v[128:131], v[252:255]
    s_nop 7
    v_mov_b32 v29, v23
    s_nop 1
    v_permlane32_swap_b32 v23, v29
    s_nop 1
    v_max_f32 v23, v23, v29
    v_mov_b32 v29, v23
    s_nop 1
    v_permlane16_swap_b32 v23, v29
    s_nop 1
    v_max_f32 v23, v23, v29
    v_mul_f32 v23, s20, v23
    v_max_f32 v23, v23, v17
    v_sub_f32 v29, v17, v23
    v_exp_f32 v29, v29
    v_mov_b32 v17, v23
    v_mul_f32 v20, v20, v29
    v_mul_f32 v160, v160, v29
    v_mul_f32 v161, v161, v29
    v_mul_f32 v162, v162, v29
    v_mul_f32 v163, v163, v29
    v_mul_f32 v172, v172, v29
    v_mul_f32 v173, v173, v29
    v_mul_f32 v174, v174, v29
    v_mul_f32 v175, v175, v29
    v_mul_f32 v184, v184, v29
    v_mul_f32 v185, v185, v29
    v_mul_f32 v186, v186, v29
    v_mul_f32 v187, v187, v29
    v_mul_f32 v196, v196, v29
    v_mul_f32 v197, v197, v29
    v_mul_f32 v198, v198, v29
    v_mul_f32 v199, v199, v29
    v_mul_f32 v208, v208, v29
    v_mul_f32 v209, v209, v29
    v_mul_f32 v210, v210, v29
    v_mul_f32 v211, v211, v29
    v_mul_f32 v220, v220, v29
    v_mul_f32 v221, v221, v29
    v_mul_f32 v222, v222, v29
    v_mul_f32 v223, v223, v29
    v_mul_f32 v232, v232, v29
    v_mul_f32 v233, v233, v29
    v_mul_f32 v234, v234, v29
    v_mul_f32 v235, v235, v29
    v_mul_f32 v244, v244, v29
    v_mul_f32 v245, v245, v29
    v_mul_f32 v246, v246, v29
    v_mul_f32 v247, v247, v29
    v_mov_b32 v29, v24
    s_nop 1
    v_permlane32_swap_b32 v24, v29
    s_nop 1
    v_max_f32 v24, v24, v29
    v_mov_b32 v29, v24
    s_nop 1
    v_permlane16_swap_b32 v24, v29
    s_nop 1
    v_max_f32 v24, v24, v29
    v_mul_f32 v24, s20, v24
    v_max_f32 v24, v24, v18
    v_sub_f32 v29, v18, v24
    v_exp_f32 v29, v29
    v_mov_b32 v18, v24
    v_mul_f32 v21, v21, v29
    v_mul_f32 v164, v164, v29
    v_mul_f32 v165, v165, v29
    v_mul_f32 v166, v166, v29
    v_mul_f32 v167, v167, v29
    v_mul_f32 v176, v176, v29
    v_mul_f32 v177, v177, v29
    v_mul_f32 v178, v178, v29
    v_mul_f32 v179, v179, v29
    v_mul_f32 v188, v188, v29
    v_mul_f32 v189, v189, v29
    v_mul_f32 v190, v190, v29
    v_mul_f32 v191, v191, v29
    v_mul_f32 v200, v200, v29
    v_mul_f32 v201, v201, v29
    v_mul_f32 v202, v202, v29
    v_mul_f32 v203, v203, v29
    v_mul_f32 v212, v212, v29
    v_mul_f32 v213, v213, v29
    v_mul_f32 v214, v214, v29
    v_mul_f32 v215, v215, v29
    v_mul_f32 v224, v224, v29
    v_mul_f32 v225, v225, v29
    v_mul_f32 v226, v226, v29
    v_mul_f32 v227, v227, v29
    v_mul_f32 v236, v236, v29
    v_mul_f32 v237, v237, v29
    v_mul_f32 v238, v238, v29
    v_mul_f32 v239, v239, v29
    v_mul_f32 v248, v248, v29
    v_mul_f32 v249, v249, v29
    v_mul_f32 v250, v250, v29
    v_mul_f32 v251, v251, v29
    v_mov_b32 v29, v25
    s_nop 1
    v_permlane32_swap_b32 v25, v29
    s_nop 1
    v_max_f32 v25, v25, v29
    v_mov_b32 v29, v25
    s_nop 1
    v_permlane16_swap_b32 v25, v29
    s_nop 1
    v_max_f32 v25, v25, v29
    v_mul_f32 v25, s20, v25
    v_max_f32 v25, v25, v19
    v_sub_f32 v29, v19, v25
    v_exp_f32 v29, v29
    v_mov_b32 v19, v25
    v_mul_f32 v22, v22, v29
    v_mul_f32 v168, v168, v29
    v_mul_f32 v169, v169, v29
    v_mul_f32 v170, v170, v29
    v_mul_f32 v171, v171, v29
    v_mul_f32 v180, v180, v29
    v_mul_f32 v181, v181, v29
    v_mul_f32 v182, v182, v29
    v_mul_f32 v183, v183, v29
    v_mul_f32 v192, v192, v29
    v_mul_f32 v193, v193, v29
    v_mul_f32 v194, v194, v29
    v_mul_f32 v195, v195, v29
    v_mul_f32 v204, v204, v29
    v_mul_f32 v205, v205, v29
    v_mul_f32 v206, v206, v29
    v_mul_f32 v207, v207, v29
    v_mul_f32 v216, v216, v29
    v_mul_f32 v217, v217, v29
    v_mul_f32 v218, v218, v29
    v_mul_f32 v219, v219, v29
    v_mul_f32 v228, v228, v29
    v_mul_f32 v229, v229, v29
    v_mul_f32 v230, v230, v29
    v_mul_f32 v231, v231, v29
    v_mul_f32 v240, v240, v29
    v_mul_f32 v241, v241, v29
    v_mul_f32 v242, v242, v29
    v_mul_f32 v243, v243, v29
    v_mul_f32 v252, v252, v29
    v_mul_f32 v253, v253, v29
    v_mul_f32 v254, v254, v29
    v_mul_f32 v255, v255, v29
    s_waitcnt lgkmcnt(0)
    ds_read_b64_tr_b16 v[80:81], v9 offset:49152
    ds_read_b64_tr_b16 v[82:83], v9 offset:53248
    ds_read_b64_tr_b16 v[84:85], v10 offset:49152
    ds_read_b64_tr_b16 v[86:87], v10 offset:53248
    ds_read_b64_tr_b16 v[88:89], v11 offset:49152
    ds_read_b64_tr_b16 v[90:91], v11 offset:53248
    ds_read_b64_tr_b16 v[92:93], v12 offset:49152
    ds_read_b64_tr_b16 v[94:95], v12 offset:53248
    ds_read_b64_tr_b16 v[96:97], v13 offset:49152
    ds_read_b64_tr_b16 v[98:99], v13 offset:53248
    ds_read_b64_tr_b16 v[100:101], v14 offset:49152
    ds_read_b64_tr_b16 v[102:103], v14 offset:53248
    ds_read_b64_tr_b16 v[104:105], v15 offset:49152
    ds_read_b64_tr_b16 v[106:107], v15 offset:53248
    ds_read_b64_tr_b16 v[108:109], v16 offset:49152
    ds_read_b64_tr_b16 v[110:111], v16 offset:53248
    v_fma_f32 v136, v136, s20, -v17
    v_fma_f32 v137, v137, s20, -v17
    v_fma_f32 v138, v138, s20, -v17
    v_fma_f32 v139, v139, s20, -v17
    v_fma_f32 v140, v140, s20, -v17
    v_fma_f32 v141, v141, s20, -v17
    v_fma_f32 v142, v142, s20, -v17
    v_fma_f32 v143, v143, s20, -v17
    v_exp_f32 v136, v136
    v_exp_f32 v137, v137
    v_exp_f32 v138, v138
    v_exp_f32 v139, v139
    v_exp_f32 v140, v140
    v_exp_f32 v141, v141
    v_exp_f32 v142, v142
    v_exp_f32 v143, v143
    v_add_f32 v20, v20, v136
    v_add_f32 v20, v20, v137
    v_add_f32 v20, v20, v138
    v_add_f32 v20, v20, v139
    v_add_f32 v20, v20, v140
    v_add_f32 v20, v20, v141
    v_add_f32 v20, v20, v142
    v_add_f32 v20, v20, v143
    v_cvt_pk_bf16_f32 v136, v136, v137
    v_cvt_pk_bf16_f32 v137, v138, v139
    v_cvt_pk_bf16_f32 v138, v140, v141
    v_cvt_pk_bf16_f32 v139, v142, v143
    v_fma_f32 v144, v144, s20, -v18
    v_fma_f32 v145, v145, s20, -v18
    v_fma_f32 v146, v146, s20, -v18
    v_fma_f32 v147, v147, s20, -v18
    v_fma_f32 v148, v148, s20, -v18
    v_fma_f32 v149, v149, s20, -v18
    v_fma_f32 v150, v150, s20, -v18
    v_fma_f32 v151, v151, s20, -v18
    v_exp_f32 v144, v144
    v_exp_f32 v145, v145
    v_exp_f32 v146, v146
    v_exp_f32 v147, v147
    v_exp_f32 v148, v148
    v_exp_f32 v149, v149
    v_exp_f32 v150, v150
    v_exp_f32 v151, v151
    v_add_f32 v21, v21, v144
    v_add_f32 v21, v21, v145
    v_add_f32 v21, v21, v146
    v_add_f32 v21, v21, v147
    v_add_f32 v21, v21, v148
    v_add_f32 v21, v21, v149
    v_add_f32 v21, v21, v150
    v_add_f32 v21, v21, v151
    v_cvt_pk_bf16_f32 v144, v144, v145
    v_cvt_pk_bf16_f32 v145, v146, v147
    v_cvt_pk_bf16_f32 v146, v148, v149
    v_cvt_pk_bf16_f32 v147, v150, v151
    v_fma_f32 v152, v152, s20, -v19
    v_fma_f32 v153, v153, s20, -v19
    v_fma_f32 v154, v154, s20, -v19
    v_fma_f32 v155, v155, s20, -v19
    v_fma_f32 v156, v156, s20, -v19
    v_fma_f32 v157, v157, s20, -v19
    v_fma_f32 v158, v158, s20, -v19
    v_fma_f32 v159, v159, s20, -v19
    v_exp_f32 v152, v152
    v_exp_f32 v153, v153
    v_exp_f32 v154, v154
    v_exp_f32 v155, v155
    v_exp_f32 v156, v156
    v_exp_f32 v157, v157
    v_exp_f32 v158, v158
    v_exp_f32 v159, v159
    v_add_f32 v22, v22, v152
    v_add_f32 v22, v22, v153
    v_add_f32 v22, v22, v154
    v_add_f32 v22, v22, v155
    v_add_f32 v22, v22, v156
    v_add_f32 v22, v22, v157
    v_add_f32 v22, v22, v158
    v_add_f32 v22, v22, v159
    v_cvt_pk_bf16_f32 v152, v152, v153
    v_cvt_pk_bf16_f32 v153, v154, v155
    v_cvt_pk_bf16_f32 v154, v156, v157
    v_cvt_pk_bf16_f32 v155, v158, v159
    s_branch L_ret3l
L_epi:
    s_waitcnt vmcnt(0) lgkmcnt(0)
    s_nop 7
    v_mov_b32 v23, v20
    s_nop 1
    v_permlane32_swap_b32 v20, v23
    s_nop 1
    v_add_f32 v20, v20, v23
    v_mov_b32 v23, v20
    s_nop 1
    v_permlane16_swap_b32 v20, v23
    s_nop 1
    v_add_f32 v20, v20, v23
    v_mov_b32 v23, v21
    s_nop 1
    v_permlane32_swap_b32 v21, v23
    s_nop 1
    v_add_f32 v21, v21, v23
    v_mov_b32 v23, v21
    s_nop 1
    v_permlane16_swap_b32 v21, v23
    s_nop 1
    v_add_f32 v21, v21, v23
    v_mov_b32 v23, v22
    s_nop 1
    v_permlane32_swap_b32 v22, v23
    s_nop 1
    v_add_f32 v22, v22, v23
    v_mov_b32 v23, v22
    s_nop 1
    v_permlane16_swap_b32 v22, v23
    s_nop 1
    v_add_f32 v22, v22, v23
    v_and_b32 v23, 15, v0
    v_lshlrev_b32 v23, 2, v23
    s_mul_i32 s43, s27, 192
    s_add_u32 s43, s43, 131072
    v_add_u32 v24, s43, v23
    v_lshlrev_b32 v25, 4, v0
    s_xor_b32 s44, s27, 4
    s_mul_i32 s45, s44, 12288
    v_add_u32 v26, s45, v25
    s_mul_i32 s45, s27, 12288
    v_add_u32 v27, s45, v25
    s_mul_i32 s44, s44, 192
    s_add_u32 s44, s44, 131072
    v_add_u32 v28, s44, v23
    s_barrier
    ds_write_b32 v24, v17 offset:0
    ds_write_b32 v24, v20 offset:2048
    ds_write_b32 v24, v18 offset:64
    ds_write_b32 v24, v21 offset:2112
    ds_write_b32 v24, v19 offset:128
    ds_write_b32 v24, v22 offset:2176
    ds_write_b128 v26, v[208:211] offset:0
    ds_write_b128 v26, v[212:215] offset:1024
    ds_write_b128 v26, v[216:219] offset:2048
    ds_write_b128 v26, v[220:223] offset:3072
    ds_write_b128 v26, v[224:227] offset:4096
    ds_write_b128 v26, v[228:231] offset:5120
    ds_write_b128 v26, v[232:235] offset:6144
    ds_write_b128 v26, v[236:239] offset:7168
    ds_write_b128 v26, v[240:243] offset:8192
    ds_write_b128 v26, v[244:247] offset:9216
    ds_write_b128 v26, v[248:251] offset:10240
    ds_write_b128 v26, v[252:255] offset:11264
    s_waitcnt lgkmcnt(0)
    s_barrier
    ds_read_b32 v112, v28 offset:0
    ds_read_b32 v115, v28 offset:2048
    ds_read_b32 v113, v28 offset:64
    ds_read_b32 v116, v28 offset:2112
    ds_read_b32 v114, v28 offset:128
    ds_read_b32 v117, v28 offset:2176
    ds_read_b128 v[208:211], v27 offset:0
    ds_read_b128 v[212:215], v27 offset:1024
    ds_read_b128 v[216:219], v27 offset:2048
    ds_read_b128 v[220:223], v27 offset:3072
    ds_read_b128 v[224:227], v27 offset:4096
    ds_read_b128 v[228:231], v27 offset:5120
    ds_read_b128 v[232:235], v27 offset:6144
    ds_read_b128 v[236:239], v27 offset:7168
    ds_read_b128 v[240:243], v27 offset:8192
    ds_read_b128 v[244:247], v27 offset:9216
    ds_read_b128 v[248:251], v27 offset:10240
    ds_read_b128 v[252:255], v27 offset:11264
    s_waitcnt lgkmcnt(0)
    v_max_f32 v30, v112, v17
    v_sub_f32 v118, v17, v30
    v_sub_f32 v112, v112, v30
    v_mov_b32 v17, v30
    v_exp_f32 v118, v118
    v_exp_f32 v112, v112
    s_nop 0
    v_mul_f32 v20, v20, v118
    v_fmac_f32 v20, v115, v112
    v_mul_f32 v160, v160, v118
    v_fmac_f32 v160, v208, v112
    v_mul_f32 v161, v161, v118
    v_fmac_f32 v161, v209, v112
    v_mul_f32 v162, v162, v118
    v_fmac_f32 v162, v210, v112
    v_mul_f32 v163, v163, v118
    v_fmac_f32 v163, v211, v112
    v_mul_f32 v172, v172, v118
    v_fmac_f32 v172, v220, v112
    v_mul_f32 v173, v173, v118
    v_fmac_f32 v173, v221, v112
    v_mul_f32 v174, v174, v118
    v_fmac_f32 v174, v222, v112
    v_mul_f32 v175, v175, v118
    v_fmac_f32 v175, v223, v112
    v_mul_f32 v184, v184, v118
    v_fmac_f32 v184, v232, v112
    v_mul_f32 v185, v185, v118
    v_fmac_f32 v185, v233, v112
    v_mul_f32 v186, v186, v118
    v_fmac_f32 v186, v234, v112
    v_mul_f32 v187, v187, v118
    v_fmac_f32 v187, v235, v112
    v_mul_f32 v196, v196, v118
    v_fmac_f32 v196, v244, v112
    v_mul_f32 v197, v197, v118
    v_fmac_f32 v197, v245, v112
    v_mul_f32 v198, v198, v118
    v_fmac_f32 v198, v246, v112
    v_mul_f32 v199, v199, v118
    v_fmac_f32 v199, v247, v112
    v_max_f32 v30, v113, v18
    v_sub_f32 v119, v18, v30
    v_sub_f32 v113, v113, v30
    v_mov_b32 v18, v30
    v_exp_f32 v119, v119
    v_exp_f32 v113, v113
    s_nop 0
    v_mul_f32 v21, v21, v119
    v_fmac_f32 v21, v116, v113
    v_mul_f32 v164, v164, v119
    v_fmac_f32 v164, v212, v113
    v_mul_f32 v165, v165, v119
    v_fmac_f32 v165, v213, v113
    v_mul_f32 v166, v166, v119
    v_fmac_f32 v166, v214, v113
    v_mul_f32 v167, v167, v119
    v_fmac_f32 v167, v215, v113
    v_mul_f32 v176, v176, v119
    v_fmac_f32 v176, v224, v113
    v_mul_f32 v177, v177, v119
    v_fmac_f32 v177, v225, v113
    v_mul_f32 v178, v178, v119
    v_fmac_f32 v178, v226, v113
    v_mul_f32 v179, v179, v119
    v_fmac_f32 v179, v227, v113
    v_mul_f32 v188, v188, v119
    v_fmac_f32 v188, v236, v113
    v_mul_f32 v189, v189, v119
    v_fmac_f32 v189, v237, v113
    v_mul_f32 v190, v190, v119
    v_fmac_f32 v190, v238, v113
    v_mul_f32 v191, v191, v119
    v_fmac_f32 v191, v239, v113
    v_mul_f32 v200, v200, v119
    v_fmac_f32 v200, v248, v113
    v_mul_f32 v201, v201, v119
    v_fmac_f32 v201, v249, v113
    v_mul_f32 v202, v202, v119
    v_fmac_f32 v202, v250, v113
    v_mul_f32 v203, v203, v119
    v_fmac_f32 v203, v251, v113
    v_max_f32 v30, v114, v19
    v_sub_f32 v120, v19, v30
    v_sub_f32 v114, v114, v30
    v_mov_b32 v19, v30
    v_exp_f32 v120, v120
    v_exp_f32 v114, v114
    s_nop 0
    v_mul_f32 v22, v22, v120
    v_fmac_f32 v22, v117, v114
    v_mul_f32 v168, v168, v120
    v_fmac_f32 v168, v216, v114
    v_mul_f32 v169, v169, v120
    v_fmac_f32 v169, v217, v114
    v_mul_f32 v170, v170, v120
    v_fmac_f32 v170, v218, v114
    v_mul_f32 v171, v171, v120
    v_fmac_f32 v171, v219, v114
    v_mul_f32 v180, v180, v120
    v_fmac_f32 v180, v228, v114
    v_mul_f32 v181, v181, v120
    v_fmac_f32 v181, v229, v114
    v_mul_f32 v182, v182, v120
    v_fmac_f32 v182, v230, v114
    v_mul_f32 v183, v183, v120
    v_fmac_f32 v183, v231, v114
    v_mul_f32 v192, v192, v120
    v_fmac_f32 v192, v240, v114
    v_mul_f32 v193, v193, v120
    v_fmac_f32 v193, v241, v114
    v_mul_f32 v194, v194, v120
    v_fmac_f32 v194, v242, v114
    v_mul_f32 v195, v195, v120
    v_fmac_f32 v195, v243, v114
    v_mul_f32 v204, v204, v120
    v_fmac_f32 v204, v252, v114
    v_mul_f32 v205, v205, v120
    v_fmac_f32 v205, v253, v114
    v_mul_f32 v206, v206, v120
    v_fmac_f32 v206, v254, v114
    v_mul_f32 v207, v207, v120
    v_fmac_f32 v207, v255, v114
    s_mul_i32 s43, s54, 49152
    s_add_u32 s12, s34, s43
    s_addc_u32 s13, s35, 0
    s_mov_b32 s14, 49152
    s_mov_b32 s15, 0x00020000
    v_and_b32 v23, 15, v0
    v_lshlrev_b32 v25, 3, v0
    s_lshl_b32 s43, s52, 1
    s_add_u32 s43, s43, s53
    s_mul_i32 s43, s43, 6144
    s_add_u32 s44, s43, 4096
    v_cvt_pk_bf16_f32 v124, v160, v161
    v_cvt_pk_bf16_f32 v125, v162, v163
    buffer_store_dwordx2 v[124:125], v25, s[12:15], s43 offen offset:0
    v_cvt_pk_bf16_f32 v126, v164, v165
    v_cvt_pk_bf16_f32 v127, v166, v167
    buffer_store_dwordx2 v[126:127], v25, s[12:15], s43 offen offset:512
    v_cvt_pk_bf16_f32 v128, v168, v169
    v_cvt_pk_bf16_f32 v129, v170, v171
    buffer_store_dwordx2 v[128:129], v25, s[12:15], s43 offen offset:1024
    v_cvt_pk_bf16_f32 v130, v172, v173
    v_cvt_pk_bf16_f32 v131, v174, v175
    buffer_store_dwordx2 v[130:131], v25, s[12:15], s43 offen offset:1536
    v_cvt_pk_bf16_f32 v132, v176, v177
    v_cvt_pk_bf16_f32 v133, v178, v179
    buffer_store_dwordx2 v[132:133], v25, s[12:15], s43 offen offset:2048
    v_cvt_pk_bf16_f32 v134, v180, v181
    v_cvt_pk_bf16_f32 v135, v182, v183
    buffer_store_dwordx2 v[134:135], v25, s[12:15], s43 offen offset:2560
    v_cvt_pk_bf16_f32 v136, v184, v185
    v_cvt_pk_bf16_f32 v137, v186, v187
    buffer_store_dwordx2 v[136:137], v25, s[12:15], s43 offen offset:3072
    v_cvt_pk_bf16_f32 v138, v188, v189
    v_cvt_pk_bf16_f32 v139, v190, v191
    buffer_store_dwordx2 v[138:139], v25, s[12:15], s43 offen offset:3584
    v_cvt_pk_bf16_f32 v140, v192, v193
    v_cvt_pk_bf16_f32 v141, v194, v195
    buffer_store_dwordx2 v[140:141], v25, s[12:15], s44 offen offset:0
    v_cvt_pk_bf16_f32 v142, v196, v197
    v_cvt_pk_bf16_f32 v143, v198, v199
    buffer_store_dwordx2 v[142:143], v25, s[12:15], s44 offen offset:512
    v_cvt_pk_bf16_f32 v144, v200, v201
    v_cvt_pk_bf16_f32 v145, v202, v203
    buffer_store_dwordx2 v[144:145], v25, s[12:15], s44 offen offset:1024
    v_cvt_pk_bf16_f32 v146, v204, v205
    v_cvt_pk_bf16_f32 v147, v206, v207
    buffer_store_dwordx2 v[146:147], v25, s[12:15], s44 offen offset:1536
    s_cmp_lg_u32 s53, 0
    s_cbranch_scc1 L_dump
    s_mul_i32 s43, s54, 1536
    s_add_u32 s43, s43, 0x2000000
    s_add_u32 s16, s34, s43
    s_addc_u32 s17, s35, 0
    s_mov_b32 s18, 1536
    s_mov_b32 s19, 0x00020000
    v_lshlrev_b32 v25, 3, v23
    s_mul_i32 s43, s52, 384
    v_add_u32 v25, s43, v25
    v_mov_b32 v112, v17
    v_mov_b32 v113, v20
    buffer_store_dwordx2 v[112:113], v25, s[16:19], 0 offen offset:0
    v_mov_b32 v114, v18
    v_mov_b32 v115, v21
    buffer_store_dwordx2 v[114:115], v25, s[16:19], 0 offen offset:128
    v_mov_b32 v116, v19
    v_mov_b32 v117, v22
    buffer_store_dwordx2 v[116:117], v25, s[16:19], 0 offen offset:256
L_dump:
L_done:
    s_endpgm
.globl gqa_combine_kernel
.p2align 8
.type gqa_combine_kernel,@function
gqa_combine_kernel:
    s_cmp_ge_u32 s2, 256
    s_cbranch_scc1 L2_done
    s_load_dwordx2 s[4:5], s[0:1], 24
    s_load_dwordx2 s[6:7], s[0:1], 40
    s_and_b32 s3, s2, 7
    s_lshl_b32 s3, s3, 2
    s_lshr_b32 s8, s2, 6
    s_add_u32 s3, s3, s8
    s_lshr_b32 s8, s2, 3
    s_and_b32 s8, s8, 7
    s_lshl_b32 s14, s3, 3
    s_add_u32 s14, s14, s8
    s_lshr_b32 s3, s14, 2
    s_and_b32 s8, s14, 3
    s_mul_i32 s9, s3, 196608
    s_mul_i32 s10, s8, 12288
    s_add_u32 s9, s9, s10
    s_mul_i32 s11, s3, 6144
    s_mul_i32 s12, s8, 384
    s_add_u32 s11, s11, s12
    s_add_u32 s11, s11, 0x2000000
    s_mul_i32 s13, s14, 12288
    s_waitcnt lgkmcnt(0)
    s_add_u32 s16, s6, s9
    s_addc_u32 s17, s7, 0
    s_mov_b32 s18, 159744
    s_mov_b32 s19, 0x00020000
    s_add_u32 s20, s6, s11
    s_addc_u32 s21, s7, 0
    s_mov_b32 s22, 4992
    s_mov_b32 s23, 0x00020000
    s_add_u32 s24, s4, s13
    s_addc_u32 s25, s5, 0
    s_mov_b32 s26, 12288
    s_mov_b32 s27, 0x00020000
    v_lshrrev_b32 v1, 6, v0
    v_and_b32 v2, 63, v0
    s_nop 0
    v_readfirstlane_b32 s31, v1
    s_lshr_b32 s32, s31, 1
    s_and_b32 s33, s31, 1
    s_mul_i32 s34, s32, 6144
    s_mul_i32 s35, s33, 3072
    s_add_u32 s34, s34, s35
    v_lshlrev_b32 v3, 3, v2
    v_add_u32 v3, s34, v3
    v_and_b32 v4, 15, v2
    v_lshlrev_b32 v5, 3, v4
    v_add_u32 v8, 3072, v5
    v_lshrrev_b32 v6, 4, v2
    v_lshlrev_b32 v7, 8, v4
    v_lshl_add_u32 v7, v6, 3, v7
    s_lshl_b32 s35, s31, 6
    v_add_u32 v7, s35, v7
    s_mov_b32 s28, 49152
    s_mov_b32 s29, 98304
    s_mov_b32 s30, 147456
    buffer_load_dwordx2 v[16:17], v5, s[20:23], 0 offen offset:0
    buffer_load_dwordx2 v[18:19], v5, s[20:23], 0 offen offset:1536
    buffer_load_dwordx2 v[20:21], v8, s[20:23], 0 offen offset:0
    buffer_load_dwordx2 v[22:23], v8, s[20:23], 0 offen offset:1536
    buffer_load_dwordx2 v[24:25], v5, s[20:23], 0 offen offset:128
    buffer_load_dwordx2 v[26:27], v5, s[20:23], 0 offen offset:1664
    buffer_load_dwordx2 v[28:29], v8, s[20:23], 0 offen offset:128
    buffer_load_dwordx2 v[30:31], v8, s[20:23], 0 offen offset:1664
    buffer_load_dwordx2 v[32:33], v5, s[20:23], 0 offen offset:256
    buffer_load_dwordx2 v[34:35], v5, s[20:23], 0 offen offset:1792
    buffer_load_dwordx2 v[36:37], v8, s[20:23], 0 offen offset:256
    buffer_load_dwordx2 v[38:39], v8, s[20:23], 0 offen offset:1792
    buffer_load_dwordx2 v[48:49], v3, s[16:19], 0 offen offset:0
    buffer_load_dwordx2 v[52:53], v3, s[16:19], s28 offen offset:0
    buffer_load_dwordx2 v[56:57], v3, s[16:19], s29 offen offset:0
    buffer_load_dwordx2 v[60:61], v3, s[16:19], s30 offen offset:0
    buffer_load_dwordx2 v[64:65], v3, s[16:19], 0 offen offset:512
    buffer_load_dwordx2 v[68:69], v3, s[16:19], s28 offen offset:512
    buffer_load_dwordx2 v[72:73], v3, s[16:19], s29 offen offset:512
    buffer_load_dwordx2 v[76:77], v3, s[16:19], s30 offen offset:512
    buffer_load_dwordx2 v[80:81], v3, s[16:19], 0 offen offset:1024
    buffer_load_dwordx2 v[84:85], v3, s[16:19], s28 offen offset:1024
    buffer_load_dwordx2 v[88:89], v3, s[16:19], s29 offen offset:1024
    buffer_load_dwordx2 v[92:93], v3, s[16:19], s30 offen offset:1024
    buffer_load_dwordx2 v[96:97], v3, s[16:19], 0 offen offset:1536
    buffer_load_dwordx2 v[100:101], v3, s[16:19], s28 offen offset:1536
    buffer_load_dwordx2 v[104:105], v3, s[16:19], s29 offen offset:1536
    buffer_load_dwordx2 v[108:109], v3, s[16:19], s30 offen offset:1536
    buffer_load_dwordx2 v[112:113], v3, s[16:19], 0 offen offset:2048
    buffer_load_dwordx2 v[116:117], v3, s[16:19], s28 offen offset:2048
    buffer_load_dwordx2 v[120:121], v3, s[16:19], s29 offen offset:2048
    buffer_load_dwordx2 v[124:125], v3, s[16:19], s30 offen offset:2048
    buffer_load_dwordx2 v[128:129], v3, s[16:19], 0 offen offset:2560
    buffer_load_dwordx2 v[132:133], v3, s[16:19], s28 offen offset:2560
    buffer_load_dwordx2 v[136:137], v3, s[16:19], s29 offen offset:2560
    buffer_load_dwordx2 v[140:141], v3, s[16:19], s30 offen offset:2560
    s_waitcnt vmcnt(24)
    v_max3_f32 v40, v16, v18, v20
    v_max_f32 v40, v40, v22
    v_sub_f32 v144, v16, v40
    v_sub_f32 v145, v18, v40
    v_sub_f32 v146, v20, v40
    v_sub_f32 v147, v22, v40
    v_exp_f32 v144, v144
    v_exp_f32 v145, v145
    v_exp_f32 v146, v146
    v_exp_f32 v147, v147
    s_nop 0
    v_mul_f32 v41, v17, v144
    v_fmac_f32 v41, v19, v145
    v_fmac_f32 v41, v21, v146
    v_fmac_f32 v41, v23, v147
    v_rcp_f32 v41, v41
    s_nop 0
    v_mul_f32 v144, v144, v41
    v_mul_f32 v145, v145, v41
    v_mul_f32 v146, v146, v41
    v_mul_f32 v147, v147, v41
    v_max3_f32 v40, v24, v26, v28
    v_max_f32 v40, v40, v30
    v_sub_f32 v148, v24, v40
    v_sub_f32 v149, v26, v40
    v_sub_f32 v150, v28, v40
    v_sub_f32 v151, v30, v40
    v_exp_f32 v148, v148
    v_exp_f32 v149, v149
    v_exp_f32 v150, v150
    v_exp_f32 v151, v151
    s_nop 0
    v_mul_f32 v41, v25, v148
    v_fmac_f32 v41, v27, v149
    v_fmac_f32 v41, v29, v150
    v_fmac_f32 v41, v31, v151
    v_rcp_f32 v41, v41
    s_nop 0
    v_mul_f32 v148, v148, v41
    v_mul_f32 v149, v149, v41
    v_mul_f32 v150, v150, v41
    v_mul_f32 v151, v151, v41
    v_max3_f32 v40, v32, v34, v36
    v_max_f32 v40, v40, v38
    v_sub_f32 v152, v32, v40
    v_sub_f32 v153, v34, v40
    v_sub_f32 v154, v36, v40
    v_sub_f32 v155, v38, v40
    v_exp_f32 v152, v152
    v_exp_f32 v153, v153
    v_exp_f32 v154, v154
    v_exp_f32 v155, v155
    s_nop 0
    v_mul_f32 v41, v33, v152
    v_fmac_f32 v41, v35, v153
    v_fmac_f32 v41, v37, v154
    v_fmac_f32 v41, v39, v155
    v_rcp_f32 v41, v41
    s_nop 0
    v_mul_f32 v152, v152, v41
    v_mul_f32 v153, v153, v41
    v_mul_f32 v154, v154, v41
    v_mul_f32 v155, v155, v41
    s_waitcnt vmcnt(20)
    v_and_b32 v51, 0xffff0000, v49
    v_lshlrev_b32 v50, 16, v49
    v_and_b32 v49, 0xffff0000, v48
    v_lshlrev_b32 v48, 16, v48
    v_and_b32 v55, 0xffff0000, v53
    v_lshlrev_b32 v54, 16, v53
    v_and_b32 v53, 0xffff0000, v52
    v_lshlrev_b32 v52, 16, v52
    v_and_b32 v59, 0xffff0000, v57
    v_lshlrev_b32 v58, 16, v57
    v_and_b32 v57, 0xffff0000, v56
    v_lshlrev_b32 v56, 16, v56
    v_and_b32 v63, 0xffff0000, v61
    v_lshlrev_b32 v62, 16, v61
    v_and_b32 v61, 0xffff0000, v60
    v_lshlrev_b32 v60, 16, v60
    v_mul_f32 v48, v48, v144
    v_fmac_f32 v48, v52, v145
    v_fmac_f32 v48, v56, v146
    v_fmac_f32 v48, v60, v147
    v_mul_f32 v49, v49, v144
    v_fmac_f32 v49, v53, v145
    v_fmac_f32 v49, v57, v146
    v_fmac_f32 v49, v61, v147
    v_mul_f32 v50, v50, v144
    v_fmac_f32 v50, v54, v145
    v_fmac_f32 v50, v58, v146
    v_fmac_f32 v50, v62, v147
    v_mul_f32 v51, v51, v144
    v_fmac_f32 v51, v55, v145
    v_fmac_f32 v51, v59, v146
    v_fmac_f32 v51, v63, v147
    v_cvt_pk_bf16_f32 v48, v48, v49
    v_cvt_pk_bf16_f32 v49, v50, v51
    v_add_u32 v10, 0, v7
    buffer_store_dwordx2 v[48:49], v10, s[24:27], 0 offen offset:0
    s_waitcnt vmcnt(17)
    v_and_b32 v67, 0xffff0000, v65
    v_lshlrev_b32 v66, 16, v65
    v_and_b32 v65, 0xffff0000, v64
    v_lshlrev_b32 v64, 16, v64
    v_and_b32 v71, 0xffff0000, v69
    v_lshlrev_b32 v70, 16, v69
    v_and_b32 v69, 0xffff0000, v68
    v_lshlrev_b32 v68, 16, v68
    v_and_b32 v75, 0xffff0000, v73
    v_lshlrev_b32 v74, 16, v73
    v_and_b32 v73, 0xffff0000, v72
    v_lshlrev_b32 v72, 16, v72
    v_and_b32 v79, 0xffff0000, v77
    v_lshlrev_b32 v78, 16, v77
    v_and_b32 v77, 0xffff0000, v76
    v_lshlrev_b32 v76, 16, v76
    v_mul_f32 v64, v64, v148
    v_fmac_f32 v64, v68, v149
    v_fmac_f32 v64, v72, v150
    v_fmac_f32 v64, v76, v151
    v_mul_f32 v65, v65, v148
    v_fmac_f32 v65, v69, v149
    v_fmac_f32 v65, v73, v150
    v_fmac_f32 v65, v77, v151
    v_mul_f32 v66, v66, v148
    v_fmac_f32 v66, v70, v149
    v_fmac_f32 v66, v74, v150
    v_fmac_f32 v66, v78, v151
    v_mul_f32 v67, v67, v148
    v_fmac_f32 v67, v71, v149
    v_fmac_f32 v67, v75, v150
    v_fmac_f32 v67, v79, v151
    v_cvt_pk_bf16_f32 v64, v64, v65
    v_cvt_pk_bf16_f32 v65, v66, v67
    v_add_u32 v10, 4096, v7
    buffer_store_dwordx2 v[64:65], v10, s[24:27], 0 offen offset:0
    s_waitcnt vmcnt(14)
    v_and_b32 v83, 0xffff0000, v81
    v_lshlrev_b32 v82, 16, v81
    v_and_b32 v81, 0xffff0000, v80
    v_lshlrev_b32 v80, 16, v80
    v_and_b32 v87, 0xffff0000, v85
    v_lshlrev_b32 v86, 16, v85
    v_and_b32 v85, 0xffff0000, v84
    v_lshlrev_b32 v84, 16, v84
    v_and_b32 v91, 0xffff0000, v89
    v_lshlrev_b32 v90, 16, v89
    v_and_b32 v89, 0xffff0000, v88
    v_lshlrev_b32 v88, 16, v88
    v_and_b32 v95, 0xffff0000, v93
    v_lshlrev_b32 v94, 16, v93
    v_and_b32 v93, 0xffff0000, v92
    v_lshlrev_b32 v92, 16, v92
    v_mul_f32 v80, v80, v152
    v_fmac_f32 v80, v84, v153
    v_fmac_f32 v80, v88, v154
    v_fmac_f32 v80, v92, v155
    v_mul_f32 v81, v81, v152
    v_fmac_f32 v81, v85, v153
    v_fmac_f32 v81, v89, v154
    v_fmac_f32 v81, v93, v155
    v_mul_f32 v82, v82, v152
    v_fmac_f32 v82, v86, v153
    v_fmac_f32 v82, v90, v154
    v_fmac_f32 v82, v94, v155
    v_mul_f32 v83, v83, v152
    v_fmac_f32 v83, v87, v153
    v_fmac_f32 v83, v91, v154
    v_fmac_f32 v83, v95, v155
    v_cvt_pk_bf16_f32 v80, v80, v81
    v_cvt_pk_bf16_f32 v81, v82, v83
    v_add_u32 v10, 8192, v7
    buffer_store_dwordx2 v[80:81], v10, s[24:27], 0 offen offset:0
    s_waitcnt vmcnt(11)
    v_and_b32 v99, 0xffff0000, v97
    v_lshlrev_b32 v98, 16, v97
    v_and_b32 v97, 0xffff0000, v96
    v_lshlrev_b32 v96, 16, v96
    v_and_b32 v103, 0xffff0000, v101
    v_lshlrev_b32 v102, 16, v101
    v_and_b32 v101, 0xffff0000, v100
    v_lshlrev_b32 v100, 16, v100
    v_and_b32 v107, 0xffff0000, v105
    v_lshlrev_b32 v106, 16, v105
    v_and_b32 v105, 0xffff0000, v104
    v_lshlrev_b32 v104, 16, v104
    v_and_b32 v111, 0xffff0000, v109
    v_lshlrev_b32 v110, 16, v109
    v_and_b32 v109, 0xffff0000, v108
    v_lshlrev_b32 v108, 16, v108
    v_mul_f32 v96, v96, v144
    v_fmac_f32 v96, v100, v145
    v_fmac_f32 v96, v104, v146
    v_fmac_f32 v96, v108, v147
    v_mul_f32 v97, v97, v144
    v_fmac_f32 v97, v101, v145
    v_fmac_f32 v97, v105, v146
    v_fmac_f32 v97, v109, v147
    v_mul_f32 v98, v98, v144
    v_fmac_f32 v98, v102, v145
    v_fmac_f32 v98, v106, v146
    v_fmac_f32 v98, v110, v147
    v_mul_f32 v99, v99, v144
    v_fmac_f32 v99, v103, v145
    v_fmac_f32 v99, v107, v146
    v_fmac_f32 v99, v111, v147
    v_cvt_pk_bf16_f32 v96, v96, v97
    v_cvt_pk_bf16_f32 v97, v98, v99
    v_add_u32 v10, 0, v7
    buffer_store_dwordx2 v[96:97], v10, s[24:27], 0 offen offset:32
    s_waitcnt vmcnt(8)
    v_and_b32 v115, 0xffff0000, v113
    v_lshlrev_b32 v114, 16, v113
    v_and_b32 v113, 0xffff0000, v112
    v_lshlrev_b32 v112, 16, v112
    v_and_b32 v119, 0xffff0000, v117
    v_lshlrev_b32 v118, 16, v117
    v_and_b32 v117, 0xffff0000, v116
    v_lshlrev_b32 v116, 16, v116
    v_and_b32 v123, 0xffff0000, v121
    v_lshlrev_b32 v122, 16, v121
    v_and_b32 v121, 0xffff0000, v120
    v_lshlrev_b32 v120, 16, v120
    v_and_b32 v127, 0xffff0000, v125
    v_lshlrev_b32 v126, 16, v125
    v_and_b32 v125, 0xffff0000, v124
    v_lshlrev_b32 v124, 16, v124
    v_mul_f32 v112, v112, v148
    v_fmac_f32 v112, v116, v149
    v_fmac_f32 v112, v120, v150
    v_fmac_f32 v112, v124, v151
    v_mul_f32 v113, v113, v148
    v_fmac_f32 v113, v117, v149
    v_fmac_f32 v113, v121, v150
    v_fmac_f32 v113, v125, v151
    v_mul_f32 v114, v114, v148
    v_fmac_f32 v114, v118, v149
    v_fmac_f32 v114, v122, v150
    v_fmac_f32 v114, v126, v151
    v_mul_f32 v115, v115, v148
    v_fmac_f32 v115, v119, v149
    v_fmac_f32 v115, v123, v150
    v_fmac_f32 v115, v127, v151
    v_cvt_pk_bf16_f32 v112, v112, v113
    v_cvt_pk_bf16_f32 v113, v114, v115
    v_add_u32 v10, 4096, v7
    buffer_store_dwordx2 v[112:113], v10, s[24:27], 0 offen offset:32
    s_waitcnt vmcnt(5)
    v_and_b32 v131, 0xffff0000, v129
    v_lshlrev_b32 v130, 16, v129
    v_and_b32 v129, 0xffff0000, v128
    v_lshlrev_b32 v128, 16, v128
    v_and_b32 v135, 0xffff0000, v133
    v_lshlrev_b32 v134, 16, v133
    v_and_b32 v133, 0xffff0000, v132
    v_lshlrev_b32 v132, 16, v132
    v_and_b32 v139, 0xffff0000, v137
    v_lshlrev_b32 v138, 16, v137
    v_and_b32 v137, 0xffff0000, v136
    v_lshlrev_b32 v136, 16, v136
    v_and_b32 v143, 0xffff0000, v141
    v_lshlrev_b32 v142, 16, v141
    v_and_b32 v141, 0xffff0000, v140
    v_lshlrev_b32 v140, 16, v140
    v_mul_f32 v128, v128, v152
    v_fmac_f32 v128, v132, v153
    v_fmac_f32 v128, v136, v154
    v_fmac_f32 v128, v140, v155
    v_mul_f32 v129, v129, v152
    v_fmac_f32 v129, v133, v153
    v_fmac_f32 v129, v137, v154
    v_fmac_f32 v129, v141, v155
    v_mul_f32 v130, v130, v152
    v_fmac_f32 v130, v134, v153
    v_fmac_f32 v130, v138, v154
    v_fmac_f32 v130, v142, v155
    v_mul_f32 v131, v131, v152
    v_fmac_f32 v131, v135, v153
    v_fmac_f32 v131, v139, v154
    v_fmac_f32 v131, v143, v155
    v_cvt_pk_bf16_f32 v128, v128, v129
    v_cvt_pk_bf16_f32 v129, v130, v131
    v_add_u32 v10, 8192, v7
    buffer_store_dwordx2 v[128:129], v10, s[24:27], 0 offen offset:32
L2_done:
    s_endpgm
.section .rodata,"a"
.p2align 6
.amdhsa_kernel standalone__gqa_softmax__near_ridge_kernel
  .amdhsa_next_free_vgpr 256
  .amdhsa_next_free_sgpr 64
  .amdhsa_accum_offset 256
  .amdhsa_group_segment_fixed_size 0
  .amdhsa_kernarg_size 48
  .amdhsa_user_sgpr_count 2
  .amdhsa_user_sgpr_kernarg_segment_ptr 1
  .amdhsa_system_sgpr_workgroup_id_x 1
.end_amdhsa_kernel
.p2align 6
.amdhsa_kernel gqa_combine_kernel
  .amdhsa_next_free_vgpr 256
  .amdhsa_next_free_sgpr 64
  .amdhsa_accum_offset 256
  .amdhsa_group_segment_fixed_size 0
  .amdhsa_kernarg_size 48
  .amdhsa_user_sgpr_count 2
  .amdhsa_user_sgpr_kernarg_segment_ptr 1
  .amdhsa_system_sgpr_workgroup_id_x 1
.end_amdhsa_kernel
```
